```python
import torch

def _softmax(x, axis=-1):
    return torch.softmax(x, dim=axis)
def _gelu(x):
    return torch.nn.functional.gelu(x, approximate="tanh")
def _silu(x):
    return torch.nn.functional.silu(x)
def _sigmoid(x):
    return torch.sigmoid(x)
def _layernorm(x, axis=-1, eps=1e-5):
    m = x.mean(dim=axis, keepdim=True)
    v = x.var(dim=axis, keepdim=True, unbiased=False)
    return (x - m) / torch.sqrt(v + eps)
def _scatter_add(tgt, idx, src, axis=0):
    return tgt.clone().index_add_(axis, idx, src)
def _segment_sum(src, seg, n):
    out = torch.zeros((n,) + src.shape[1:], dtype=src.dtype)
    return out.index_add_(0, seg, src)
def _pad(x, pw):
    flat = tuple(v for pair in reversed(pw) for v in pair)
    return torch.nn.functional.pad(x, flat)

kernel_name = 'standalone__mixer_token_mlp__prompt'

def setup_inputs():

    _w = (lambda a: (lambda t: t.to(torch.bfloat16) if t.is_floating_point() else t)(torch.as_tensor(a)))
    B, S, D, F = 1, 2048, 448, 1792
    return {
        "x": _w((lambda *s: torch.randn(*s, dtype=torch.bfloat16) * 0.05)(B, S, D)),
        "w1": _w((lambda *s: torch.randn(*s, dtype=torch.bfloat16) * 0.2)(S, F) * (S ** -0.5)),
        "b1": _w((lambda *s: torch.randn(*s, dtype=torch.bfloat16) * 3.2)(F) * 0.02),
        "w2": _w((lambda *s: torch.randn(*s, dtype=torch.bfloat16) * 0.05)(F, S) * (F ** -0.5)),
        "b2": _w((lambda *s: torch.randn(*s, dtype=torch.bfloat16) * 0.1)(S) * 0.02),
    }

def reference(x, w1, b1, w2, b2):
    B, S, D = x.shape
    h = _layernorm(x, axis=-1)
    u = torch.einsum("bsd,sf->bdf", h, w1) + b1
    u = _gelu(u)
    y = torch.einsum("bdf,fs->bds", u, w2) + b2
    return (lambda x, *d: x.permute(*d))(y, 0, 2, 1)
```

```asm
; @launch grid=(256,1,1) block=(256,1,1) lds=163840
.amdgcn_target "amdgcn-amd-amdhsa--gfx950"
.text
.globl standalone__mixer_token_mlp__prompt_kernel
.p2align 8
.type standalone__mixer_token_mlp__prompt_kernel,@function
standalone__mixer_token_mlp__prompt_kernel:
  s_cmp_ge_u32 s2, 256
  s_cbranch_scc1 L_done
  s_load_dwordx16 s[4:19], s[0:1], 0
  s_getpc_b64 s[96:97]
  v_lshlrev_b32 v2, 6, v0
  v_min_u32 v2, L_done - standalone__mixer_token_mlp__prompt_kernel - 1024, v2
  global_load_dword v51, v2, s[96:97] offset:768
  v_and_b32 v1, 63, v0
  v_lshrrev_b32 v2, 6, v0
  v_lshlrev_b32 v14, 4, v1
  v_readfirstlane_b32 s48, v2
  s_and_b32 s66, s2, 7
  s_bfe_u32 s56, s2, 0x20003
  s_lshr_b32 s54, s2, 5
  s_min_u32 s55, s54, 6
  s_lshl_b32 s53, s66, 2
  s_add_u32 s53, s53, s56
  s_add_u32 s3, s53, 4
  s_mul_i32 s3, s3, 9363
  s_lshr_b32 s3, s3, 16
  s_add_u32 s3, s3, s53
  s_lshl_b32 s67, s56, 3
  s_add_u32 s67, s67, 3
  s_cmp_eq_u32 s66, 7
  s_cselect_b32 s3, s67, s3
  s_cmp_lt_u32 s66, 7
  s_cselect_b32 s26, 0x700000, 0
  s_max_u32 s66, s66, s54
  s_cmp_lt_u32 s66, 7
  s_cselect_b32 s64, 1, 0
  s_cmp_lg_u32 s54, 6
  s_cselect_b32 s66, 2, 0
  s_or_b32 s64, s64, s66
  s_lshr_b32 s49, s48, 1
  s_and_b32 s50, s48, 1
  s_mul_i32 s51, s48, 40960
  v_and_b32 v2, 31, v1
  v_lshrrev_b32 v3, 5, v1
  v_cmp_gt_u32 vcc, 28, v2
  v_lshlrev_b32 v2, 4, v2
  v_mul_u32_u24 v40, 896, v3
  v_add_u32 v40, v40, v2
  v_mov_b32 v41, 0x7ff00000
  v_cndmask_b32 v40, v41, v40, vcc
  s_mov_b64 s[70:71], vcc
  s_lshr_b32 s66, s2, 1
  s_lshl_b32 s66, s66, 4
  s_and_b32 s68, s2, 1
  s_lshl_b32 s68, s68, 2
  s_add_u32 s66, s66, s68
  s_lshl_b32 s68, s50, 1
  s_add_u32 s66, s66, s68
  s_lshl_b32 s68, s49, 3
  s_add_u32 s66, s66, s68
  s_mul_i32 s66, s66, 896
  v_mov_b32 v15, 0
  s_and_b32 s59, s2, 7
  s_xor_b32 s59, s59, s54
  s_lshl_b32 s59, s59, 2
  s_or_b32 s62, s59, s56
  s_lshr_b32 s59, s62, 1
  s_mov_b32 s60, 114688
  s_lshl_b32 s58, s53, 7
  s_mul_i32 s67, s48, 1835008
  s_add_u32 s58, s58, s67
  v_lshrrev_b32 v2, 3, v1
  v_mul_u32_u24 v4, 3584, v2
  v_lshlrev_b32 v8, 12, v2
  v_bfe_u32 v2, v1, 4, 1
  v_lshlrev_b32 v2, 2, v2
  v_and_b32 v3, 7, v1
  v_xor_b32 v3, v3, v2
  v_lshlrev_b32 v3, 4, v3
  v_add_u32 v4, v4, v3
  v_add_u32 v8, v8, v3
  v_add_u32 v5, 27648, v4
  v_add_u32 v6, 55296, v4
  v_add_u32 v7, 82944, v4
  s_mov_b32 s68, 0x1f8000
  s_waitcnt lgkmcnt(0)
  s_mov_b32 s20, s4
  s_mov_b32 s21, s5
  s_mov_b32 s22, 0x1c0000
  s_mov_b32 s23, 0x20000
  buffer_load_dwordx4 v[128:131], v40, s[20:23], s66 offen
  buffer_load_dwordx4 v[132:135], v40, s[20:23], s66 offen offset:448
  s_mov_b32 s32, s18
  s_mov_b32 s33, s19
  s_mov_b32 s34, 0x3b9000
  s_mov_b32 s35, 0x20000
  buffer_load_dword v15, v15, s[32:35], s68 offen sc1
  s_mov_b32 s24, s6
  s_mov_b32 s25, s7
  s_mov_b32 s27, 0x20000
  s_xor_b32 s57, s59, 0
  s_mul_i32 s57, s57, s60
  s_add_u32 m0, s51, 0
  s_add_u32 s57, s57, s58
  buffer_load_dwordx4 v4, s[24:27], s57 offen offset:0 lds
  buffer_load_dwordx4 v5, s[24:27], s57 offen offset:1024 lds
  buffer_load_dwordx4 v6, s[24:27], s57 offen offset:2048 lds
  buffer_load_dwordx4 v7, s[24:27], s57 offen offset:3072 lds
  s_xor_b32 s57, s59, 1
  s_mul_i32 s57, s57, s60
  s_add_u32 m0, s51, 4096
  s_add_u32 s57, s57, s58
  buffer_load_dwordx4 v4, s[24:27], s57 offen offset:0 lds
  buffer_load_dwordx4 v5, s[24:27], s57 offen offset:1024 lds
  buffer_load_dwordx4 v6, s[24:27], s57 offen offset:2048 lds
  buffer_load_dwordx4 v7, s[24:27], s57 offen offset:3072 lds
  s_mov_b32 s28, s10
  s_mov_b32 s29, s11
  s_mov_b32 s30, 0x700000
  s_mov_b32 s31, 0x20000
  s_bitcmp1_b32 s64, 1
  s_cselect_b32 s30, s30, 0
  s_mov_b32 s36, s14
  s_mov_b32 s37, s15
  s_mov_b32 s38, 0x1c0000
  s_mov_b32 s39, 0x20000
  s_mov_b32 s40, s8
  s_mov_b32 s41, s9
  s_mov_b32 s42, 0xe00
  s_mov_b32 s43, 0x20000
  s_mov_b32 s44, s12
  s_mov_b32 s45, s13
  s_mov_b32 s46, 0x1000
  s_mov_b32 s47, 0x20000
  s_lshl_b32 s66, s50, 8
  v_xor_b32 v12, s66, v14
  s_mul_i32 s63, s54, 229376
  s_lshl_b32 s66, s53, 12
  s_add_u32 s63, s63, s66
  s_lshl_b32 s66, s48, 10
  s_add_u32 s63, s63, s66
  s_add_u32 s63, s63, 0x200000
  v_add_u32 v9, 31744, v8
  v_add_u32 v10, 63488, v8
  v_add_u32 v11, 95232, v8
  s_lshl_b32 s23, s3, 7
  s_mul_i32 s67, s48, 1835008
  s_add_u32 s23, s23, s67
  s_bitcmp1_b32 s64, 0
  s_cselect_b32 s26, s26, 0
  v_bfe_u32 v2, v1, 2, 2
  v_lshrrev_b32 v3, 5, v1
  v_lshl_add_u32 v3, v3, 2, v2
  v_lshlrev_b32 v16, 7, v3
  v_bfe_u32 v3, v1, 4, 1
  v_lshl_add_u32 v16, v3, 5, v16
  v_and_b32 v3, 3, v1
  v_lshl_add_u32 v16, v3, 3, v16
  v_lshrrev_b32 v2, 1, v2
  v_xor_b32 v2, s49, v2
  v_lshl_add_u32 v16, v2, 6, v16
  s_and_b32 s66, s56, 1
  s_lshl_b32 s66, s66, 11
  s_add_u32 s66, s66, s51
  v_add_u32 v16, s66, v16
  v_xor_b32 v17, 64, v16
  v_xor_b32 v18, 0x800, v16
  v_xor_b32 v19, 0x840, v16
  s_lshl_b32 s66, s50, 5
  v_xor_b32 v52, s66, v16
  v_xor_b32 v53, s66, v17
  v_xor_b32 v54, s66, v18
  v_xor_b32 v55, s66, v19
  v_lshrrev_b32 v3, 5, v1
  v_mul_u32_u24 v41, 1088, v3
  v_and_b32 v2, 31, v1
  v_lshl_add_u32 v41, v2, 4, v41
  s_mul_i32 s66, s48, 2176
  s_add_u32 s66, s66, 28672
  v_add_u32 v41, s66, v41
  v_mov_b32 v2, 37376
  v_cndmask_b32 v41, v2, v41, s[70:71]
  v_bfe_u32 v2, v1, 2, 2
  v_mul_u32_u24 v42, 1088, v2
  v_lshrrev_b32 v2, 4, v1
  v_lshl_add_u32 v42, v2, 5, v42
  v_and_b32 v2, 3, v1
  v_lshl_add_u32 v42, v2, 3, v42
  s_lshl_b32 s66, s48, 7
  s_add_u32 s66, s66, 28672
  v_add_u32 v42, s66, v42
  v_lshrrev_b32 v2, 5, v1
  v_and_b32 v3, 31, v1
  v_lshlrev_b32 v43, 4, v3
  v_lshl_add_u32 v43, v2, 17, v43
  v_mul_u32_u24 v49, 896, v3
  v_lshl_add_u32 v49, v2, 4, v49
  v_lshlrev_b32 v36, 3, v2
  v_lshlrev_b32 v37, 1, v3
  s_cmp_eq_u32 s48, 3
  s_cselect_b32 s66, 1, 2
  v_lshlrev_b32 v44, 14, v1
  v_cmp_gt_u32 vcc, s66, v1
  v_mov_b32 v2, 0x7ff00000
  v_lshlrev_b32 v38, 4, v1
  v_cndmask_b32 v44, v2, v44, vcc
  v_cmp_eq_u32 vcc, 0, v1
  v_min_u32 v39, 27, v1
  v_lshlrev_b32 v39, 7, v39
  v_cndmask_b32 v48, v2, v1, vcc
  s_lshl_b32 s20, s2, 9
  s_lshl_b32 s67, s48, 18
  s_add_u32 s20, s20, s67
  s_add_u32 s21, s20, 1048576
  s_cmp_eq_u32 s48, 3
  s_cselect_b32 s21, 0x7ff00000, s21
  s_lshl_b32 s22, s48, 8
  s_add_u32 s22, s22, s2
  s_lshl_b32 s22, s22, 4
  s_add_u32 s22, s22, 0x1c0000
  s_lshl_b32 s69, s54, 2
  s_add_u32 s69, s69, s48
  s_lshl_b32 s69, s69, 10
  s_add_u32 s69, s69, 0x1c0000
  s_lshl_b32 s62, s62, 10
  s_lshl_b32 s66, s54, 18
  s_add_u32 s62, s62, s66
  s_lshl_b32 s66, s48, 15
  s_add_u32 s62, s62, s66
  s_mul_i32 s66, s55, 229376
  s_mul_i32 s67, s48, 28672
  s_add_u32 s66, s66, s67
  s_add_u32 s68, s66, 0x200000
  s_xor_b32 s66, s56, 0
  s_lshl_b32 s66, s66, 10
  s_add_u32 s4, s68, s66
  s_xor_b32 s66, s56, 1
  s_lshl_b32 s66, s66, 10
  s_add_u32 s5, s68, s66
  s_xor_b32 s66, s56, 2
  s_lshl_b32 s66, s66, 10
  s_add_u32 s6, s68, s66
  s_xor_b32 s66, s56, 3
  s_lshl_b32 s66, s66, 10
  s_add_u32 s7, s68, s66
  s_and_b32 s66, s2, 7
  s_cmp_eq_u32 s66, 7
  s_cselect_b32 s67, s55, 0
  s_add_u32 s66, s66, s67
  s_sub_u32 s67, s66, 7
  s_cmp_ge_u32 s66, 7
  s_cselect_b32 s66, s67, s66
  s_bitcmp1_b32 s64, 1
  s_cselect_b32 s66, s66, 0
  s_lshl_b32 s8, s66, 12
  s_add_u32 s9, s8, 4096
  s_cmp_eq_u32 s9, 28672
  s_cselect_b32 s9, 0, s9
  s_add_u32 s10, s9, 4096
  s_cmp_eq_u32 s10, 28672
  s_cselect_b32 s10, 0, s10
  s_add_u32 s11, s10, 4096
  s_cmp_eq_u32 s11, 28672
  s_cselect_b32 s11, 0, s11
  s_add_u32 s12, s11, 4096
  s_cmp_eq_u32 s12, 28672
  s_cselect_b32 s12, 0, s12
  s_add_u32 s13, s12, 4096
  s_cmp_eq_u32 s13, 28672
  s_cselect_b32 s13, 0, s13
  s_add_u32 s14, s13, 4096
  s_cmp_eq_u32 s14, 28672
  s_cselect_b32 s14, 0, s14
  s_mul_i32 s100, s54, 28
  s_add_u32 s100, s100, s53
  s_lshl_b32 s100, s100, 2
  s_add_u32 s100, s100, s48
  s_lshl_b32 s100, s100, 7
  s_add_u32 s100, s100, 0x388000
  s_lshl_b32 s101, s55, 2
  s_add_u32 s101, s101, s48
  s_mul_i32 s101, s101, 3584
  s_add_u32 s101, s101, 0x388000
  s_lshl_b32 s15, s3, 6
  s_lshl_b32 s67, s49, 5
  s_add_u32 s15, s15, s67
  s_lshl_b32 s65, s15, 1
  s_lshl_b32 s68, s53, 6
  s_add_u32 s68, s68, s67
  s_lshl_b32 s68, s68, 1
  s_mul_i32 s15, s15, 896
  s_lshl_b32 s67, s55, 7
  s_add_u32 s15, s15, s67
  s_lshl_b32 s67, s50, 5
  s_add_u32 s15, s15, s67
  s_add_u32 s68, s68, s67
  s_mov_b32 s0, s68
  s_mov_b32 s1, s65
  v_add_u32 v20, s51, v14
  s_xor_b32 s66, s48, 1
  s_mul_i32 s66, s66, 40960
  v_add_u32 v21, s66, v14
  s_xor_b32 s66, s48, 2
  s_mul_i32 s66, s66, 40960
  v_add_u32 v22, s66, v14
  s_xor_b32 s66, s48, 3
  s_mul_i32 s66, s66, 40960
  v_add_u32 v23, s66, v14
  s_waitcnt vmcnt(9)
  v_lshlrev_b32 v144, 16, v128
  v_and_b32 v145, 0xffff0000, v128
  v_lshlrev_b32 v146, 16, v129
  v_and_b32 v147, 0xffff0000, v129
  v_lshlrev_b32 v148, 16, v130
  v_and_b32 v149, 0xffff0000, v130
  v_lshlrev_b32 v150, 16, v131
  v_and_b32 v151, 0xffff0000, v131
  v_lshlrev_b32 v152, 16, v132
  v_and_b32 v153, 0xffff0000, v132
  v_lshlrev_b32 v154, 16, v133
  v_and_b32 v155, 0xffff0000, v133
  v_lshlrev_b32 v156, 16, v134
  v_and_b32 v157, 0xffff0000, v134
  v_lshlrev_b32 v158, 16, v135
  v_and_b32 v159, 0xffff0000, v135
  v_pk_add_f32 v[176:177], v[144:145], v[146:147]
  v_pk_add_f32 v[178:179], v[148:149], v[150:151]
  v_pk_add_f32 v[180:181], v[152:153], v[154:155]
  v_pk_add_f32 v[182:183], v[156:157], v[158:159]
  v_pk_add_f32 v[176:177], v[176:177], v[178:179]
  v_pk_add_f32 v[180:181], v[180:181], v[182:183]
  v_pk_add_f32 v[176:177], v[176:177], v[180:181]
  v_add_f32 v176, v176, v177
  s_nop 1
  v_add_f32_dpp v176, v176, v176 row_ror:8 row_mask:0xf bank_mask:0xf
  s_nop 1
  v_add_f32_dpp v176, v176, v176 row_ror:4 row_mask:0xf bank_mask:0xf
  s_nop 1
  v_add_f32_dpp v176, v176, v176 row_ror:2 row_mask:0xf bank_mask:0xf
  s_nop 1
  v_add_f32_dpp v176, v176, v176 row_ror:1 row_mask:0xf bank_mask:0xf
  v_mov_b32 v177, v176
  s_nop 1
  v_permlane16_swap_b32 v176, v177
  s_nop 1
  v_add_f32 v176, v176, v177
  v_mul_f32 v176, 0x3b124925, v176
  v_cndmask_b32 v178, 0, v176, s[70:71]
  v_pk_add_f32 v[160:161], v[144:145], v[178:179] op_sel_hi:[1,0] neg_lo:[0,1] neg_hi:[0,1]
  v_pk_add_f32 v[162:163], v[146:147], v[178:179] op_sel_hi:[1,0] neg_lo:[0,1] neg_hi:[0,1]
  v_pk_add_f32 v[164:165], v[148:149], v[178:179] op_sel_hi:[1,0] neg_lo:[0,1] neg_hi:[0,1]
  v_pk_add_f32 v[166:167], v[150:151], v[178:179] op_sel_hi:[1,0] neg_lo:[0,1] neg_hi:[0,1]
  v_pk_add_f32 v[168:169], v[152:153], v[178:179] op_sel_hi:[1,0] neg_lo:[0,1] neg_hi:[0,1]
  v_pk_add_f32 v[170:171], v[154:155], v[178:179] op_sel_hi:[1,0] neg_lo:[0,1] neg_hi:[0,1]
  v_pk_add_f32 v[172:173], v[156:157], v[178:179] op_sel_hi:[1,0] neg_lo:[0,1] neg_hi:[0,1]
  v_pk_add_f32 v[174:175], v[158:159], v[178:179] op_sel_hi:[1,0] neg_lo:[0,1] neg_hi:[0,1]
  v_pk_mul_f32 v[180:181], v[160:161], v[160:161]
  v_pk_mul_f32 v[182:183], v[162:163], v[162:163]
  v_pk_fma_f32 v[180:181], v[164:165], v[164:165], v[180:181]
  v_pk_fma_f32 v[182:183], v[166:167], v[166:167], v[182:183]
  v_pk_fma_f32 v[180:181], v[168:169], v[168:169], v[180:181]
  v_pk_fma_f32 v[182:183], v[170:171], v[170:171], v[182:183]
  v_pk_fma_f32 v[180:181], v[172:173], v[172:173], v[180:181]
  v_pk_fma_f32 v[182:183], v[174:175], v[174:175], v[182:183]
  v_pk_add_f32 v[180:181], v[180:181], v[182:183]
  v_add_f32 v180, v180, v181
  v_cvt_pk_bf16_f32 v176, v176, v176
  v_and_b32 v176, 0xffff0000, v176
  s_nop 1
  v_add_f32_dpp v180, v180, v180 row_ror:8 row_mask:0xf bank_mask:0xf
  s_nop 1
  v_add_f32_dpp v180, v180, v180 row_ror:4 row_mask:0xf bank_mask:0xf
  s_nop 1
  v_add_f32_dpp v180, v180, v180 row_ror:2 row_mask:0xf bank_mask:0xf
  s_nop 1
  v_add_f32_dpp v180, v180, v180 row_ror:1 row_mask:0xf bank_mask:0xf
  v_mov_b32 v181, v180
  s_nop 1
  v_permlane16_swap_b32 v180, v181
  s_nop 1
  v_add_f32 v180, v180, v181
  v_mul_f32 v180, 0x3b124925, v180
  v_cvt_pk_bf16_f32 v180, v180, v180
  v_and_b32 v180, 0xffff0000, v180
  v_add_f32 v180, 0x3727c5ac, v180
  v_cvt_pk_bf16_f32 v180, v180, v180
  v_and_b32 v180, 0xffff0000, v180
  v_sqrt_f32 v180, v180
  v_pk_add_f32 v[160:161], v[144:145], v[176:177] op_sel_hi:[1,0] neg_lo:[0,1] neg_hi:[0,1]
  v_pk_add_f32 v[162:163], v[146:147], v[176:177] op_sel_hi:[1,0] neg_lo:[0,1] neg_hi:[0,1]
  v_pk_add_f32 v[164:165], v[148:149], v[176:177] op_sel_hi:[1,0] neg_lo:[0,1] neg_hi:[0,1]
  v_pk_add_f32 v[166:167], v[150:151], v[176:177] op_sel_hi:[1,0] neg_lo:[0,1] neg_hi:[0,1]
  v_pk_add_f32 v[168:169], v[152:153], v[176:177] op_sel_hi:[1,0] neg_lo:[0,1] neg_hi:[0,1]
  v_pk_add_f32 v[170:171], v[154:155], v[176:177] op_sel_hi:[1,0] neg_lo:[0,1] neg_hi:[0,1]
  v_pk_add_f32 v[172:173], v[156:157], v[176:177] op_sel_hi:[1,0] neg_lo:[0,1] neg_hi:[0,1]
  v_pk_add_f32 v[174:175], v[158:159], v[176:177] op_sel_hi:[1,0] neg_lo:[0,1] neg_hi:[0,1]
  v_cvt_pk_bf16_f32 v180, v180, v180
  v_and_b32 v180, 0xffff0000, v180
  v_rcp_f32 v180, v180
  s_nop 0
  v_pk_mul_f32 v[160:161], v[160:161], v[180:181] op_sel_hi:[1,0]
  v_pk_mul_f32 v[162:163], v[162:163], v[180:181] op_sel_hi:[1,0]
  v_pk_mul_f32 v[164:165], v[164:165], v[180:181] op_sel_hi:[1,0]
  v_pk_mul_f32 v[166:167], v[166:167], v[180:181] op_sel_hi:[1,0]
  v_pk_mul_f32 v[168:169], v[168:169], v[180:181] op_sel_hi:[1,0]
  v_pk_mul_f32 v[170:171], v[170:171], v[180:181] op_sel_hi:[1,0]
  v_pk_mul_f32 v[172:173], v[172:173], v[180:181] op_sel_hi:[1,0]
  v_pk_mul_f32 v[174:175], v[174:175], v[180:181] op_sel_hi:[1,0]
  v_cvt_pk_bf16_f32 v128, v160, v161
  v_cvt_pk_bf16_f32 v129, v162, v163
  v_cvt_pk_bf16_f32 v130, v164, v165
  v_cvt_pk_bf16_f32 v131, v166, v167
  v_cvt_pk_bf16_f32 v132, v168, v169
  v_cvt_pk_bf16_f32 v133, v170, v171
  v_cvt_pk_bf16_f32 v134, v172, v173
  v_cvt_pk_bf16_f32 v135, v174, v175
  ds_write_b128 v41, v[128:131]
  ds_write_b128 v41, v[132:135] offset:448
  s_waitcnt vmcnt(8) lgkmcnt(0)
  s_barrier
  ds_read_b64_tr_b16 v[144:145], v42 offset:0
  ds_read_b64_tr_b16 v[146:147], v42 offset:4352
  ds_read_b64_tr_b16 v[148:149], v42 offset:512
  ds_read_b64_tr_b16 v[150:151], v42 offset:4864
  v_readfirstlane_b32 s52, v15
  s_waitcnt lgkmcnt(2)
  buffer_store_dwordx4 v[144:147], v43, s[32:35], s20 offen sc1
  s_waitcnt lgkmcnt(0)
  buffer_store_dwordx4 v[148:151], v43, s[32:35], s21 offen sc1
  s_mul_i32 s52, s52, 0x9e3779b1
  s_add_u32 s52, s52, 0x7f4a7c15
  v_mov_b32 v50, s52
  s_lshr_b32 s66, s56, 1
  s_lshl_b32 s66, s66, 17
  s_add_u32 s16, s23, s66
  s_xor_b32 s66, s66, 0x20000
  s_add_u32 s17, s23, s66
  s_barrier
  s_bitcmp1_b32 s64, 0
  s_cbranch_scc0 L_roleC
  s_xor_b32 s57, s59, 2
  s_mul_i32 s57, s57, s60
  s_add_u32 m0, s51, 8192
  s_add_u32 s57, s57, s58
  buffer_load_dwordx4 v4, s[24:27], s57 offen offset:0 lds
  buffer_load_dwordx4 v5, s[24:27], s57 offen offset:1024 lds
  buffer_load_dwordx4 v6, s[24:27], s57 offen offset:2048 lds
  buffer_load_dwordx4 v7, s[24:27], s57 offen offset:3072 lds
  s_xor_b32 s57, s59, 3
  s_mul_i32 s57, s57, s60
  s_add_u32 m0, s51, 12288
  s_add_u32 s57, s57, s58
  buffer_load_dwordx4 v4, s[24:27], s57 offen offset:0 lds
  buffer_load_dwordx4 v5, s[24:27], s57 offen offset:1024 lds
  buffer_load_dwordx4 v6, s[24:27], s57 offen offset:2048 lds
  buffer_load_dwordx4 v7, s[24:27], s57 offen offset:3072 lds
  s_xor_b32 s57, s59, 4
  s_mul_i32 s57, s57, s60
  s_add_u32 m0, s51, 16384
  s_add_u32 s57, s57, s58
  buffer_load_dwordx4 v4, s[24:27], s57 offen offset:0 lds
  buffer_load_dwordx4 v5, s[24:27], s57 offen offset:1024 lds
  buffer_load_dwordx4 v6, s[24:27], s57 offen offset:2048 lds
  buffer_load_dwordx4 v7, s[24:27], s57 offen offset:3072 lds
  s_waitcnt vmcnt(12)
  buffer_store_dword v50, v44, s[32:35], s22 offen sc1
  s_mov_b32 s65, 0
  s_xor_b32 s57, s59, 5
  s_mul_i32 s57, s57, s60
  s_add_u32 m0, s51, 20480
  s_add_u32 s57, s57, s58
  buffer_load_dwordx4 v4, s[24:27], s57 offen offset:0 lds
  buffer_load_dwordx4 v5, s[24:27], s57 offen offset:1024 lds
  buffer_load_dwordx4 v6, s[24:27], s57 offen offset:2048 lds
  buffer_load_dwordx4 v7, s[24:27], s57 offen offset:3072 lds
  ds_read_b64_tr_b16 a[0:1], v52 offset:0
  ds_read_b64_tr_b16 a[2:3], v52 offset:1024
  ds_read_b64_tr_b16 a[4:5], v53 offset:0
  ds_read_b64_tr_b16 a[6:7], v53 offset:1024
  ds_read_b64_tr_b16 a[8:9], v54 offset:0
  ds_read_b64_tr_b16 a[10:11], v54 offset:1024
  ds_read_b64_tr_b16 a[12:13], v55 offset:0
  ds_read_b64_tr_b16 a[14:15], v55 offset:1024
  ds_read_b64_tr_b16 a[16:17], v52 offset:4096
  ds_read_b64_tr_b16 a[18:19], v52 offset:5120
  ds_read_b64_tr_b16 a[20:21], v53 offset:4096
  ds_read_b64_tr_b16 a[22:23], v53 offset:5120
  ds_read_b64_tr_b16 a[24:25], v54 offset:4096
  ds_read_b64_tr_b16 a[26:27], v54 offset:5120
  ds_read_b64_tr_b16 a[28:29], v55 offset:4096
  ds_read_b64_tr_b16 a[30:31], v55 offset:5120
  s_xor_b32 s57, s59, 6
  s_mul_i32 s57, s57, s60
  s_add_u32 m0, s51, 24576
  s_add_u32 s57, s57, s58
  buffer_load_dwordx4 v4, s[24:27], s57 offen offset:0 lds
  buffer_load_dwordx4 v5, s[24:27], s57 offen offset:1024 lds
  buffer_load_dwordx4 v6, s[24:27], s57 offen offset:2048 lds
  buffer_load_dwordx4 v7, s[24:27], s57 offen offset:3072 lds
  s_waitcnt vmcnt(17)
  ds_read_b64_tr_b16 a[32:33], v52 offset:8192
  ds_read_b64_tr_b16 a[34:35], v52 offset:9216
  ds_read_b64_tr_b16 a[36:37], v53 offset:8192
  ds_read_b64_tr_b16 a[38:39], v53 offset:9216
  ds_read_b64_tr_b16 a[40:41], v54 offset:8192
  ds_read_b64_tr_b16 a[42:43], v54 offset:9216
  ds_read_b64_tr_b16 a[44:45], v55 offset:8192
  ds_read_b64_tr_b16 a[46:47], v55 offset:9216
  s_xor_b32 s57, s59, 7
  s_mul_i32 s57, s57, s60
  s_add_u32 m0, s51, 28672
  s_add_u32 s57, s57, s58
  buffer_load_dwordx4 v4, s[24:27], s57 offen offset:0 lds
  buffer_load_dwordx4 v5, s[24:27], s57 offen offset:1024 lds
  buffer_load_dwordx4 v6, s[24:27], s57 offen offset:2048 lds
  buffer_load_dwordx4 v7, s[24:27], s57 offen offset:3072 lds
  s_waitcnt vmcnt(17)
  ds_read_b64_tr_b16 a[48:49], v52 offset:12288
  ds_read_b64_tr_b16 a[50:51], v52 offset:13312
  ds_read_b64_tr_b16 a[52:53], v53 offset:12288
  ds_read_b64_tr_b16 a[54:55], v53 offset:13312
  ds_read_b64_tr_b16 a[56:57], v54 offset:12288
  ds_read_b64_tr_b16 a[58:59], v54 offset:13312
  ds_read_b64_tr_b16 a[60:61], v55 offset:12288
  ds_read_b64_tr_b16 a[62:63], v55 offset:13312
  s_xor_b32 s57, s59, 8
  s_mul_i32 s57, s57, s60
  s_add_u32 m0, s51, 32768
  s_add_u32 s57, s57, s58
  buffer_load_dwordx4 v4, s[24:27], s57 offen offset:0 lds
  buffer_load_dwordx4 v5, s[24:27], s57 offen offset:1024 lds
  buffer_load_dwordx4 v6, s[24:27], s57 offen offset:2048 lds
  buffer_load_dwordx4 v7, s[24:27], s57 offen offset:3072 lds
  s_waitcnt vmcnt(17)
  ds_read_b64_tr_b16 a[64:65], v52 offset:16384
  ds_read_b64_tr_b16 a[66:67], v52 offset:17408
  ds_read_b64_tr_b16 a[68:69], v53 offset:16384
  ds_read_b64_tr_b16 a[70:71], v53 offset:17408
  ds_read_b64_tr_b16 a[72:73], v54 offset:16384
  ds_read_b64_tr_b16 a[74:75], v54 offset:17408
  ds_read_b64_tr_b16 a[76:77], v55 offset:16384
  ds_read_b64_tr_b16 a[78:79], v55 offset:17408
  s_xor_b32 s57, s59, 9
  s_mul_i32 s57, s57, s60
  s_add_u32 m0, s51, 36864
  s_add_u32 s57, s57, s58
  buffer_load_dwordx4 v4, s[24:27], s57 offen offset:0 lds
  buffer_load_dwordx4 v5, s[24:27], s57 offen offset:1024 lds
  buffer_load_dwordx4 v6, s[24:27], s57 offen offset:2048 lds
  buffer_load_dwordx4 v7, s[24:27], s57 offen offset:3072 lds
  s_waitcnt vmcnt(16)
  ds_read_b64_tr_b16 a[80:81], v52 offset:20480
  ds_read_b64_tr_b16 a[82:83], v52 offset:21504
  ds_read_b64_tr_b16 a[84:85], v53 offset:20480
  ds_read_b64_tr_b16 a[86:87], v53 offset:21504
  ds_read_b64_tr_b16 a[88:89], v54 offset:20480
  ds_read_b64_tr_b16 a[90:91], v54 offset:21504
  ds_read_b64_tr_b16 a[92:93], v55 offset:20480
  ds_read_b64_tr_b16 a[94:95], v55 offset:21504
  s_waitcnt lgkmcnt(0)
  s_xor_b32 s57, s59, 10
  s_mul_i32 s57, s57, s60
  s_add_u32 m0, s51, 0
  s_add_u32 s57, s57, s58
  buffer_load_dwordx4 v4, s[24:27], s57 offen offset:0 lds
  buffer_load_dwordx4 v5, s[24:27], s57 offen offset:1024 lds
  buffer_load_dwordx4 v6, s[24:27], s57 offen offset:2048 lds
  buffer_load_dwordx4 v7, s[24:27], s57 offen offset:3072 lds
  s_waitcnt vmcnt(16)
  ds_read_b64_tr_b16 a[96:97], v52 offset:24576
  ds_read_b64_tr_b16 a[98:99], v52 offset:25600
  ds_read_b64_tr_b16 a[100:101], v53 offset:24576
  ds_read_b64_tr_b16 a[102:103], v53 offset:25600
  ds_read_b64_tr_b16 a[104:105], v54 offset:24576
  ds_read_b64_tr_b16 a[106:107], v54 offset:25600
  ds_read_b64_tr_b16 a[108:109], v55 offset:24576
  ds_read_b64_tr_b16 a[110:111], v55 offset:25600
  s_xor_b32 s57, s59, 11
  s_mul_i32 s57, s57, s60
  s_add_u32 m0, s51, 4096
  s_add_u32 s57, s57, s58
  buffer_load_dwordx4 v4, s[24:27], s57 offen offset:0 lds
  buffer_load_dwordx4 v5, s[24:27], s57 offen offset:1024 lds
  buffer_load_dwordx4 v6, s[24:27], s57 offen offset:2048 lds
  buffer_load_dwordx4 v7, s[24:27], s57 offen offset:3072 lds
  s_waitcnt vmcnt(16)
  ds_read_b64_tr_b16 a[112:113], v52 offset:28672
  ds_read_b64_tr_b16 a[114:115], v52 offset:29696
  ds_read_b64_tr_b16 a[116:117], v53 offset:28672
  ds_read_b64_tr_b16 a[118:119], v53 offset:29696
  ds_read_b64_tr_b16 a[120:121], v54 offset:28672
  ds_read_b64_tr_b16 a[122:123], v54 offset:29696
  ds_read_b64_tr_b16 a[124:125], v55 offset:28672
  ds_read_b64_tr_b16 a[126:127], v55 offset:29696
  buffer_load_dword v33, v38, s[32:35], s69 offen sc1
  s_xor_b32 s57, s59, 12
  s_mul_i32 s57, s57, s60
  s_add_u32 m0, s51, 8192
  s_add_u32 s57, s57, s58
  buffer_load_dwordx4 v4, s[24:27], s57 offen offset:0 lds
  buffer_load_dwordx4 v5, s[24:27], s57 offen offset:1024 lds
  buffer_load_dwordx4 v6, s[24:27], s57 offen offset:2048 lds
  buffer_load_dwordx4 v7, s[24:27], s57 offen offset:3072 lds
  s_waitcnt vmcnt(17)
  ds_read_b64_tr_b16 a[128:129], v52 offset:32768
  ds_read_b64_tr_b16 a[130:131], v52 offset:33792
  ds_read_b64_tr_b16 a[132:133], v53 offset:32768
  ds_read_b64_tr_b16 a[134:135], v53 offset:33792
  ds_read_b64_tr_b16 a[136:137], v54 offset:32768
  ds_read_b64_tr_b16 a[138:139], v54 offset:33792
  ds_read_b64_tr_b16 a[140:141], v55 offset:32768
  ds_read_b64_tr_b16 a[142:143], v55 offset:33792
  s_xor_b32 s57, s59, 13
  s_mul_i32 s57, s57, s60
  s_add_u32 m0, s51, 12288
  s_add_u32 s57, s57, s58
  buffer_load_dwordx4 v4, s[24:27], s57 offen offset:0 lds
  buffer_load_dwordx4 v5, s[24:27], s57 offen offset:1024 lds
  buffer_load_dwordx4 v6, s[24:27], s57 offen offset:2048 lds
  buffer_load_dwordx4 v7, s[24:27], s57 offen offset:3072 lds
  s_waitcnt vmcnt(17)
  ds_read_b64_tr_b16 a[144:145], v52 offset:36864
  ds_read_b64_tr_b16 a[146:147], v52 offset:37888
  ds_read_b64_tr_b16 a[148:149], v53 offset:36864
  ds_read_b64_tr_b16 a[150:151], v53 offset:37888
  ds_read_b64_tr_b16 a[152:153], v54 offset:36864
  ds_read_b64_tr_b16 a[154:155], v54 offset:37888
  ds_read_b64_tr_b16 a[156:157], v55 offset:36864
  ds_read_b64_tr_b16 a[158:159], v55 offset:37888
  s_xor_b32 s57, s59, 14
  s_mul_i32 s57, s57, s60
  s_add_u32 m0, s51, 16384
  s_add_u32 s57, s57, s58
  buffer_load_dwordx4 v4, s[24:27], s57 offen offset:0 lds
  buffer_load_dwordx4 v5, s[24:27], s57 offen offset:1024 lds
  buffer_load_dwordx4 v6, s[24:27], s57 offen offset:2048 lds
  buffer_load_dwordx4 v7, s[24:27], s57 offen offset:3072 lds
  s_waitcnt vmcnt(17)
  ds_read_b64_tr_b16 a[160:161], v52 offset:0
  ds_read_b64_tr_b16 a[162:163], v52 offset:1024
  ds_read_b64_tr_b16 a[164:165], v53 offset:0
  ds_read_b64_tr_b16 a[166:167], v53 offset:1024
  ds_read_b64_tr_b16 a[168:169], v54 offset:0
  ds_read_b64_tr_b16 a[170:171], v54 offset:1024
  ds_read_b64_tr_b16 a[172:173], v55 offset:0
  ds_read_b64_tr_b16 a[174:175], v55 offset:1024
  s_xor_b32 s57, s59, 15
  s_mul_i32 s57, s57, s60
  s_add_u32 m0, s51, 20480
  s_add_u32 s57, s57, s58
  buffer_load_dwordx4 v4, s[24:27], s57 offen offset:0 lds
  buffer_load_dwordx4 v5, s[24:27], s57 offen offset:1024 lds
  buffer_load_dwordx4 v6, s[24:27], s57 offen offset:2048 lds
  buffer_load_dwordx4 v7, s[24:27], s57 offen offset:3072 lds
  s_waitcnt vmcnt(17)
  ds_read_b64_tr_b16 a[176:177], v52 offset:4096
  ds_read_b64_tr_b16 a[178:179], v52 offset:5120
  ds_read_b64_tr_b16 a[180:181], v53 offset:4096
  ds_read_b64_tr_b16 a[182:183], v53 offset:5120
  ds_read_b64_tr_b16 a[184:185], v54 offset:4096
  ds_read_b64_tr_b16 a[186:187], v54 offset:5120
  ds_read_b64_tr_b16 a[188:189], v55 offset:4096
  ds_read_b64_tr_b16 a[190:191], v55 offset:5120
  s_waitcnt vmcnt(16)
  v_cmp_ne_u32 vcc, s52, v33
  s_cbranch_vccz L_p1_ok
L_p1_loop:
  buffer_load_dword v33, v38, s[32:35], s69 offen sc1
  s_add_u32 s65, s65, 1
  s_cmp_ge_u32 s65, 0x20000
  s_cbranch_scc1 L_p1_ok
  s_waitcnt vmcnt(0)
  v_cmp_ne_u32 vcc, s52, v33
  s_cbranch_vccz L_p1_ok
  s_sleep 4
  s_branch L_p1_loop
L_p1_ok:
  buffer_load_dwordx2 v[24:25], v36, s[40:43], s0 offen offset:0
  buffer_load_dwordx2 v[26:27], v36, s[40:43], s0 offen offset:16
  buffer_load_ushort v32, v37, s[44:47], s1 offen
  s_xor_b32 s61, s62, 0x0
  buffer_load_dwordx4 v[128:131], v14, s[32:35], s61 offen sc1
  s_xor_b32 s61, s62, 0x400
  buffer_load_dwordx4 v[132:135], v14, s[32:35], s61 offen sc1
  s_xor_b32 s61, s62, 0x800
  buffer_load_dwordx4 v[136:139], v14, s[32:35], s61 offen sc1
  s_waitcnt vmcnt(18)
  ds_read_b64_tr_b16 a[192:193], v52 offset:8192
  ds_read_b64_tr_b16 a[194:195], v52 offset:9216
  ds_read_b64_tr_b16 a[196:197], v53 offset:8192
  ds_read_b64_tr_b16 a[198:199], v53 offset:9216
  ds_read_b64_tr_b16 a[200:201], v54 offset:8192
  ds_read_b64_tr_b16 a[202:203], v54 offset:9216
  ds_read_b64_tr_b16 a[204:205], v55 offset:8192
  ds_read_b64_tr_b16 a[206:207], v55 offset:9216
  s_xor_b32 s61, s62, 0xc00
  buffer_load_dwordx4 v[140:143], v14, s[32:35], s61 offen sc1
  s_xor_b32 s61, s62, 0x1000
  buffer_load_dwordx4 v[144:147], v14, s[32:35], s61 offen sc1
  s_xor_b32 s61, s62, 0x1400
  buffer_load_dwordx4 v[148:151], v14, s[32:35], s61 offen sc1
  s_waitcnt vmcnt(17)
  ds_read_b64_tr_b16 a[208:209], v52 offset:12288
  ds_read_b64_tr_b16 a[210:211], v52 offset:13312
  ds_read_b64_tr_b16 a[212:213], v53 offset:12288
  ds_read_b64_tr_b16 a[214:215], v53 offset:13312
  ds_read_b64_tr_b16 a[216:217], v54 offset:12288
  ds_read_b64_tr_b16 a[218:219], v54 offset:13312
  ds_read_b64_tr_b16 a[220:221], v55 offset:12288
  ds_read_b64_tr_b16 a[222:223], v55 offset:13312
  s_xor_b32 s61, s62, 0x1800
  buffer_load_dwordx4 v[152:155], v14, s[32:35], s61 offen sc1
  s_xor_b32 s61, s62, 0x1c00
  buffer_load_dwordx4 v[156:159], v14, s[32:35], s61 offen sc1
  s_xor_b32 s61, s62, 0x2000
  buffer_load_dwordx4 v[160:163], v14, s[32:35], s61 offen sc1
  s_waitcnt vmcnt(16)
  ds_read_b64_tr_b16 a[224:225], v52 offset:16384
  ds_read_b64_tr_b16 a[226:227], v52 offset:17408
  ds_read_b64_tr_b16 a[228:229], v53 offset:16384
  ds_read_b64_tr_b16 a[230:231], v53 offset:17408
  ds_read_b64_tr_b16 a[232:233], v54 offset:16384
  ds_read_b64_tr_b16 a[234:235], v54 offset:17408
  ds_read_b64_tr_b16 a[236:237], v55 offset:16384
  ds_read_b64_tr_b16 a[238:239], v55 offset:17408
  s_xor_b32 s61, s62, 0x2400
  buffer_load_dwordx4 v[164:167], v14, s[32:35], s61 offen sc1
  s_xor_b32 s61, s62, 0x2800
  buffer_load_dwordx4 v[168:171], v14, s[32:35], s61 offen sc1
  s_waitcnt vmcnt(14)
  ds_read_b64_tr_b16 a[240:241], v52 offset:20480
  ds_read_b64_tr_b16 a[242:243], v52 offset:21504
  ds_read_b64_tr_b16 a[244:245], v53 offset:20480
  ds_read_b64_tr_b16 a[246:247], v53 offset:21504
  ds_read_b64_tr_b16 a[248:249], v54 offset:20480
  ds_read_b64_tr_b16 a[250:251], v54 offset:21504
  ds_read_b64_tr_b16 a[252:253], v55 offset:20480
  ds_read_b64_tr_b16 a[254:255], v55 offset:21504
  s_waitcnt vmcnt(11)
  v_lshlrev_b32 v56, 16, v24
  v_and_b32 v57, 0xffff0000, v24
  v_lshlrev_b32 v58, 16, v25
  v_and_b32 v59, 0xffff0000, v25
  v_lshlrev_b32 v60, 16, v26
  v_and_b32 v61, 0xffff0000, v26
  v_lshlrev_b32 v62, 16, v27
  v_and_b32 v63, 0xffff0000, v27
  v_lshlrev_b32 v32, 16, v32
  s_mov_b32 s70, 0xbdd2d3e8
  s_mov_b32 s71, 0xbdd2d3e8
  v_mov_b32 v34, 0xc0135761
  v_mov_b32 v35, 0xc0135761
  s_waitcnt lgkmcnt(0)
  s_waitcnt vmcnt(10)
  v_mfma_f32_32x32x16_bf16 v[80:95], a[4:7], v[128:131], 0
  s_xor_b32 s61, s62, 0x2c00
  buffer_load_dwordx4 v[172:175], v14, s[32:35], s61 offen sc1
  v_mfma_f32_32x32x16_bf16 v[64:79], a[0:3], v[128:131], 0
  s_waitcnt vmcnt(10)
  v_mfma_f32_32x32x16_bf16 v[80:95], a[12:15], v[132:135], v[80:95]
  s_xor_b32 s61, s62, 0x3000
  buffer_load_dwordx4 v[176:179], v14, s[32:35], s61 offen sc1
  v_mfma_f32_32x32x16_bf16 v[64:79], a[8:11], v[132:135], v[64:79]
  s_waitcnt vmcnt(10)
  v_mfma_f32_32x32x16_bf16 v[80:95], a[20:23], v[136:139], v[80:95]
  s_xor_b32 s61, s62, 0x3400
  buffer_load_dwordx4 v[180:183], v14, s[32:35], s61 offen sc1
  v_mfma_f32_32x32x16_bf16 v[64:79], a[16:19], v[136:139], v[64:79]
  s_waitcnt vmcnt(10)
  v_mfma_f32_32x32x16_bf16 v[80:95], a[28:31], v[140:143], v[80:95]
  s_xor_b32 s61, s62, 0x3800
  buffer_load_dwordx4 v[184:187], v14, s[32:35], s61 offen sc1
  v_mfma_f32_32x32x16_bf16 v[64:79], a[24:27], v[140:143], v[64:79]
  s_waitcnt vmcnt(10)
  v_mfma_f32_32x32x16_bf16 v[80:95], a[36:39], v[144:147], v[80:95]
  s_xor_b32 s61, s62, 0x3c00
  buffer_load_dwordx4 v[188:191], v14, s[32:35], s61 offen sc1
  v_mfma_f32_32x32x16_bf16 v[64:79], a[32:35], v[144:147], v[64:79]
  s_waitcnt vmcnt(10)
  v_mfma_f32_32x32x16_bf16 v[80:95], a[44:47], v[148:151], v[80:95]
  s_xor_b32 s61, s62, 0x4000
  buffer_load_dwordx4 v[128:131], v14, s[32:35], s61 offen sc1
  v_mfma_f32_32x32x16_bf16 v[64:79], a[40:43], v[148:151], v[64:79]
  s_waitcnt vmcnt(10)
  v_mfma_f32_32x32x16_bf16 v[80:95], a[52:55], v[152:155], v[80:95]
  s_xor_b32 s61, s62, 0x4400
  buffer_load_dwordx4 v[132:135], v14, s[32:35], s61 offen sc1
  v_mfma_f32_32x32x16_bf16 v[64:79], a[48:51], v[152:155], v[64:79]
  s_waitcnt vmcnt(10)
  v_mfma_f32_32x32x16_bf16 v[80:95], a[60:63], v[156:159], v[80:95]
  s_xor_b32 s61, s62, 0x4800
  buffer_load_dwordx4 v[136:139], v14, s[32:35], s61 offen sc1
  v_mfma_f32_32x32x16_bf16 v[64:79], a[56:59], v[156:159], v[64:79]
  s_waitcnt vmcnt(10)
  v_mfma_f32_32x32x16_bf16 v[80:95], a[68:71], v[160:163], v[80:95]
  s_xor_b32 s61, s62, 0x4c00
  buffer_load_dwordx4 v[140:143], v14, s[32:35], s61 offen sc1
  v_mfma_f32_32x32x16_bf16 v[64:79], a[64:67], v[160:163], v[64:79]
  s_waitcnt vmcnt(10)
  v_mfma_f32_32x32x16_bf16 v[80:95], a[76:79], v[164:167], v[80:95]
  s_xor_b32 s61, s62, 0x5000
  buffer_load_dwordx4 v[144:147], v14, s[32:35], s61 offen sc1
  v_mfma_f32_32x32x16_bf16 v[64:79], a[72:75], v[164:167], v[64:79]
  s_waitcnt vmcnt(10)
  v_mfma_f32_32x32x16_bf16 v[80:95], a[84:87], v[168:171], v[80:95]
  s_xor_b32 s61, s62, 0x5400
  buffer_load_dwordx4 v[148:151], v14, s[32:35], s61 offen sc1
  v_mfma_f32_32x32x16_bf16 v[64:79], a[80:83], v[168:171], v[64:79]
  s_waitcnt vmcnt(10)
  v_mfma_f32_32x32x16_bf16 v[80:95], a[92:95], v[172:175], v[80:95]
  s_xor_b32 s61, s62, 0x5800
  buffer_load_dwordx4 v[152:155], v14, s[32:35], s61 offen sc1
  v_mfma_f32_32x32x16_bf16 v[64:79], a[88:91], v[172:175], v[64:79]
  s_waitcnt vmcnt(10)
  v_mfma_f32_32x32x16_bf16 v[80:95], a[100:103], v[176:179], v[80:95]
  s_xor_b32 s61, s62, 0x5c00
  buffer_load_dwordx4 v[156:159], v14, s[32:35], s61 offen sc1
  v_mfma_f32_32x32x16_bf16 v[64:79], a[96:99], v[176:179], v[64:79]
  s_waitcnt vmcnt(10)
  v_mfma_f32_32x32x16_bf16 v[80:95], a[108:111], v[180:183], v[80:95]
  s_xor_b32 s61, s62, 0x6000
  buffer_load_dwordx4 v[160:163], v14, s[32:35], s61 offen sc1
  v_mfma_f32_32x32x16_bf16 v[64:79], a[104:107], v[180:183], v[64:79]
  s_waitcnt vmcnt(10)
  v_mfma_f32_32x32x16_bf16 v[80:95], a[116:119], v[184:187], v[80:95]
  s_xor_b32 s61, s62, 0x6400
  buffer_load_dwordx4 v[164:167], v14, s[32:35], s61 offen sc1
  v_mfma_f32_32x32x16_bf16 v[64:79], a[112:115], v[184:187], v[64:79]
  s_waitcnt vmcnt(10)
  v_mfma_f32_32x32x16_bf16 v[80:95], a[124:127], v[188:191], v[80:95]
  s_xor_b32 s61, s62, 0x6800
  buffer_load_dwordx4 v[168:171], v14, s[32:35], s61 offen sc1
  v_mfma_f32_32x32x16_bf16 v[64:79], a[120:123], v[188:191], v[64:79]
  s_waitcnt vmcnt(10)
  v_mfma_f32_32x32x16_bf16 v[80:95], a[132:135], v[128:131], v[80:95]
  s_xor_b32 s61, s62, 0x6c00
  buffer_load_dwordx4 v[172:175], v14, s[32:35], s61 offen sc1
  v_mfma_f32_32x32x16_bf16 v[64:79], a[128:131], v[128:131], v[64:79]
  s_waitcnt vmcnt(10)
  v_mfma_f32_32x32x16_bf16 v[80:95], a[140:143], v[132:135], v[80:95]
  s_xor_b32 s61, s62, 0x7000
  buffer_load_dwordx4 v[176:179], v14, s[32:35], s61 offen sc1
  v_mfma_f32_32x32x16_bf16 v[64:79], a[136:139], v[132:135], v[64:79]
  s_waitcnt vmcnt(10)
  v_mfma_f32_32x32x16_bf16 v[80:95], a[148:151], v[136:139], v[80:95]
  s_xor_b32 s61, s62, 0x7400
  buffer_load_dwordx4 v[180:183], v14, s[32:35], s61 offen sc1
  v_mfma_f32_32x32x16_bf16 v[64:79], a[144:147], v[136:139], v[64:79]
  s_waitcnt vmcnt(10)
  v_mfma_f32_32x32x16_bf16 v[80:95], a[156:159], v[140:143], v[80:95]
  s_xor_b32 s61, s62, 0x7800
  buffer_load_dwordx4 v[184:187], v14, s[32:35], s61 offen sc1
  v_mfma_f32_32x32x16_bf16 v[64:79], a[152:155], v[140:143], v[64:79]
  s_waitcnt vmcnt(10)
  v_mfma_f32_32x32x16_bf16 v[80:95], a[164:167], v[144:147], v[80:95]
  s_xor_b32 s61, s62, 0x7c00
  buffer_load_dwordx4 v[188:191], v14, s[32:35], s61 offen sc1
  v_mfma_f32_32x32x16_bf16 v[64:79], a[160:163], v[144:147], v[64:79]
  s_waitcnt vmcnt(10)
  v_mfma_f32_32x32x16_bf16 v[80:95], a[172:175], v[148:151], v[80:95]
  s_xor_b32 s61, s62, 0x20000
  buffer_load_dwordx4 v[128:131], v14, s[32:35], s61 offen sc1
  v_mfma_f32_32x32x16_bf16 v[64:79], a[168:171], v[148:151], v[64:79]
  s_waitcnt vmcnt(10)
  v_mfma_f32_32x32x16_bf16 v[80:95], a[180:183], v[152:155], v[80:95]
  s_xor_b32 s61, s62, 0x20400
  buffer_load_dwordx4 v[132:135], v14, s[32:35], s61 offen sc1
  v_mfma_f32_32x32x16_bf16 v[64:79], a[176:179], v[152:155], v[64:79]
  s_waitcnt vmcnt(10)
  v_mfma_f32_32x32x16_bf16 v[80:95], a[188:191], v[156:159], v[80:95]
  s_xor_b32 s61, s62, 0x20800
  buffer_load_dwordx4 v[136:139], v14, s[32:35], s61 offen sc1
  v_mfma_f32_32x32x16_bf16 v[64:79], a[184:187], v[156:159], v[64:79]
  s_waitcnt vmcnt(10)
  v_mfma_f32_32x32x16_bf16 v[80:95], a[196:199], v[160:163], v[80:95]
  s_xor_b32 s61, s62, 0x20c00
  buffer_load_dwordx4 v[140:143], v14, s[32:35], s61 offen sc1
  v_mfma_f32_32x32x16_bf16 v[64:79], a[192:195], v[160:163], v[64:79]
  s_waitcnt vmcnt(10)
  v_mfma_f32_32x32x16_bf16 v[80:95], a[204:207], v[164:167], v[80:95]
  s_xor_b32 s61, s62, 0x21000
  buffer_load_dwordx4 v[144:147], v14, s[32:35], s61 offen sc1
  v_mfma_f32_32x32x16_bf16 v[64:79], a[200:203], v[164:167], v[64:79]
  s_waitcnt vmcnt(10)
  v_mfma_f32_32x32x16_bf16 v[80:95], a[212:215], v[168:171], v[80:95]
  s_xor_b32 s61, s62, 0x21400
  buffer_load_dwordx4 v[148:151], v14, s[32:35], s61 offen sc1
  v_mfma_f32_32x32x16_bf16 v[64:79], a[208:211], v[168:171], v[64:79]
  s_waitcnt vmcnt(10)
  v_mfma_f32_32x32x16_bf16 v[80:95], a[220:223], v[172:175], v[80:95]
  s_xor_b32 s61, s62, 0x21800
  buffer_load_dwordx4 v[152:155], v14, s[32:35], s61 offen sc1
  v_mfma_f32_32x32x16_bf16 v[64:79], a[216:219], v[172:175], v[64:79]
  s_waitcnt vmcnt(10)
  v_mfma_f32_32x32x16_bf16 v[80:95], a[228:231], v[176:179], v[80:95]
  s_xor_b32 s61, s62, 0x21c00
  buffer_load_dwordx4 v[156:159], v14, s[32:35], s61 offen sc1
  v_mfma_f32_32x32x16_bf16 v[64:79], a[224:227], v[176:179], v[64:79]
  s_waitcnt vmcnt(10)
  v_mfma_f32_32x32x16_bf16 v[80:95], a[236:239], v[180:183], v[80:95]
  s_xor_b32 s61, s62, 0x22000
  buffer_load_dwordx4 v[160:163], v14, s[32:35], s61 offen sc1
  v_mfma_f32_32x32x16_bf16 v[64:79], a[232:235], v[180:183], v[64:79]
  s_waitcnt vmcnt(10)
  v_mfma_f32_32x32x16_bf16 v[80:95], a[244:247], v[184:187], v[80:95]
  s_xor_b32 s61, s62, 0x22400
  buffer_load_dwordx4 v[164:167], v14, s[32:35], s61 offen sc1
  v_mfma_f32_32x32x16_bf16 v[64:79], a[240:243], v[184:187], v[64:79]
  s_waitcnt vmcnt(10)
  v_mfma_f32_32x32x16_bf16 v[80:95], a[252:255], v[188:191], v[80:95]
  s_xor_b32 s61, s62, 0x22800
  buffer_load_dwordx4 v[168:171], v14, s[32:35], s61 offen sc1
  v_mfma_f32_32x32x16_bf16 v[64:79], a[248:251], v[188:191], v[64:79]
  s_waitcnt vmcnt(10)
  v_mfma_f32_32x32x16_bf16 v[112:127], a[4:7], v[128:131], 0
  s_xor_b32 s61, s62, 0x22c00
  buffer_load_dwordx4 v[172:175], v14, s[32:35], s61 offen sc1
  v_mfma_f32_32x32x16_bf16 v[96:111], a[0:3], v[128:131], 0
  s_waitcnt vmcnt(10)
  v_mfma_f32_32x32x16_bf16 v[112:127], a[12:15], v[132:135], v[112:127]
  s_xor_b32 s61, s62, 0x23000
  buffer_load_dwordx4 v[176:179], v14, s[32:35], s61 offen sc1
  v_mfma_f32_32x32x16_bf16 v[96:111], a[8:11], v[132:135], v[96:111]
  s_waitcnt vmcnt(10)
  v_mfma_f32_32x32x16_bf16 v[112:127], a[20:23], v[136:139], v[112:127]
  s_xor_b32 s61, s62, 0x23400
  buffer_load_dwordx4 v[180:183], v14, s[32:35], s61 offen sc1
  v_mfma_f32_32x32x16_bf16 v[96:111], a[16:19], v[136:139], v[96:111]
  ds_write_b128 v20, v[88:91] offset:32768
  ds_write_b128 v20, v[92:95] offset:33792
  s_waitcnt vmcnt(10)
  v_mfma_f32_32x32x16_bf16 v[112:127], a[28:31], v[140:143], v[112:127]
  s_xor_b32 s61, s62, 0x23800
  buffer_load_dwordx4 v[184:187], v14, s[32:35], s61 offen sc1
  v_mfma_f32_32x32x16_bf16 v[96:111], a[24:27], v[140:143], v[96:111]
  ds_write_b128 v20, v[80:83] offset:30720
  ds_write_b128 v20, v[84:87] offset:31744
  s_waitcnt vmcnt(10)
  v_mfma_f32_32x32x16_bf16 v[112:127], a[36:39], v[144:147], v[112:127]
  s_xor_b32 s61, s62, 0x23c00
  buffer_load_dwordx4 v[188:191], v14, s[32:35], s61 offen sc1
  v_mfma_f32_32x32x16_bf16 v[96:111], a[32:35], v[144:147], v[96:111]
  ds_write_b128 v20, v[72:75] offset:28672
  ds_write_b128 v20, v[76:79] offset:29696
  s_waitcnt vmcnt(10)
  v_mfma_f32_32x32x16_bf16 v[112:127], a[44:47], v[148:151], v[112:127]
  s_xor_b32 s61, s62, 0x24000
  buffer_load_dwordx4 v[128:131], v14, s[32:35], s61 offen sc1
  v_mfma_f32_32x32x16_bf16 v[96:111], a[40:43], v[148:151], v[96:111]
  v_add_f32 v64, v64, v56
  v_add_f32 v65, v65, v57
  v_add_f32 v66, v66, v58
  v_add_f32 v67, v67, v59
  v_add_f32 v68, v68, v60
  v_add_f32 v69, v69, v61
  v_add_f32 v70, v70, v62
  s_waitcnt vmcnt(10)
  v_mfma_f32_32x32x16_bf16 v[112:127], a[52:55], v[152:155], v[112:127]
  s_xor_b32 s61, s62, 0x24400
  buffer_load_dwordx4 v[132:135], v14, s[32:35], s61 offen sc1
  v_mfma_f32_32x32x16_bf16 v[96:111], a[48:51], v[152:155], v[96:111]
  v_add_f32 v71, v71, v63
  s_waitcnt vmcnt(10)
  v_mfma_f32_32x32x16_bf16 v[112:127], a[60:63], v[156:159], v[112:127]
  s_xor_b32 s61, s62, 0x24800
  buffer_load_dwordx4 v[136:139], v14, s[32:35], s61 offen sc1
  v_mfma_f32_32x32x16_bf16 v[96:111], a[56:59], v[156:159], v[96:111]
  s_waitcnt lgkmcnt(0)
  s_barrier
  ds_read_b128 v[192:195], v21 offset:28672
  ds_read_b128 v[196:199], v21 offset:29696
  ds_read_b128 v[200:203], v22 offset:30720
  ds_read_b128 v[204:207], v22 offset:31744
  ds_read_b128 v[208:211], v23 offset:32768
  ds_read_b128 v[212:215], v23 offset:33792
  s_waitcnt vmcnt(10)
  v_mfma_f32_32x32x16_bf16 v[112:127], a[68:71], v[160:163], v[112:127]
  s_xor_b32 s61, s62, 0x24c00
  buffer_load_dwordx4 v[140:143], v14, s[32:35], s61 offen sc1
  v_mfma_f32_32x32x16_bf16 v[96:111], a[64:67], v[160:163], v[96:111]
  s_waitcnt vmcnt(10)
  v_mfma_f32_32x32x16_bf16 v[112:127], a[76:79], v[164:167], v[112:127]
  s_xor_b32 s61, s62, 0x25000
  buffer_load_dwordx4 v[144:147], v14, s[32:35], s61 offen sc1
  v_mfma_f32_32x32x16_bf16 v[96:111], a[72:75], v[164:167], v[96:111]
  s_waitcnt lgkmcnt(0)
  s_waitcnt vmcnt(10)
  v_mfma_f32_32x32x16_bf16 v[112:127], a[84:87], v[168:171], v[112:127]
  s_xor_b32 s61, s62, 0x25400
  buffer_load_dwordx4 v[148:151], v14, s[32:35], s61 offen sc1
  v_mfma_f32_32x32x16_bf16 v[96:111], a[80:83], v[168:171], v[96:111]
  v_add_f32 v192, v192, v200
  v_add_f32 v193, v193, v201
  v_add_f32 v194, v194, v202
  v_add_f32 v195, v195, v203
  v_add_f32 v196, v196, v204
  v_add_f32 v197, v197, v205
  v_add_f32 v198, v198, v206
  s_waitcnt vmcnt(10)
  v_mfma_f32_32x32x16_bf16 v[112:127], a[92:95], v[172:175], v[112:127]
  s_xor_b32 s61, s62, 0x25800
  buffer_load_dwordx4 v[152:155], v14, s[32:35], s61 offen sc1
  v_mfma_f32_32x32x16_bf16 v[96:111], a[88:91], v[172:175], v[96:111]
  v_add_f32 v199, v199, v207
  v_add_f32 v64, v64, v208
  v_add_f32 v65, v65, v209
  v_add_f32 v66, v66, v210
  v_add_f32 v67, v67, v211
  v_add_f32 v68, v68, v212
  v_add_f32 v69, v69, v213
  s_waitcnt vmcnt(10)
  v_mfma_f32_32x32x16_bf16 v[112:127], a[100:103], v[176:179], v[112:127]
  s_xor_b32 s61, s62, 0x25c00
  buffer_load_dwordx4 v[156:159], v14, s[32:35], s61 offen sc1
  v_mfma_f32_32x32x16_bf16 v[96:111], a[96:99], v[176:179], v[96:111]
  v_add_f32 v70, v70, v214
  v_add_f32 v71, v71, v215
  v_add_f32 v64, v64, v192
  v_add_f32 v65, v65, v193
  v_add_f32 v66, v66, v194
  v_add_f32 v67, v67, v195
  v_add_f32 v68, v68, v196
  s_waitcnt vmcnt(10)
  v_mfma_f32_32x32x16_bf16 v[112:127], a[108:111], v[180:183], v[112:127]
  s_xor_b32 s61, s62, 0x26000
  buffer_load_dwordx4 v[160:163], v14, s[32:35], s61 offen sc1
  v_mfma_f32_32x32x16_bf16 v[96:111], a[104:107], v[180:183], v[96:111]
  v_add_f32 v69, v69, v197
  v_add_f32 v70, v70, v198
  v_add_f32 v71, v71, v199
  v_mul_f32 v192, v64, v64
  v_mul_f32 v193, v65, v65
  v_mul_f32 v194, v66, v66
  v_mul_f32 v195, v67, v67
  s_waitcnt vmcnt(10)
  v_mfma_f32_32x32x16_bf16 v[112:127], a[116:119], v[184:187], v[112:127]
  s_xor_b32 s61, s62, 0x26400
  buffer_load_dwordx4 v[164:167], v14, s[32:35], s61 offen sc1
  v_mfma_f32_32x32x16_bf16 v[96:111], a[112:115], v[184:187], v[96:111]
  v_mul_f32 v196, v68, v68
  v_mul_f32 v197, v69, v69
  v_mul_f32 v198, v70, v70
  v_mul_f32 v199, v71, v71
  v_fma_f32 v192, v192, s70, v34
  v_fma_f32 v193, v193, s70, v34
  v_fma_f32 v194, v194, s70, v34
  s_waitcnt vmcnt(10)
  v_mfma_f32_32x32x16_bf16 v[112:127], a[124:127], v[188:191], v[112:127]
  s_xor_b32 s61, s62, 0x26800
  buffer_load_dwordx4 v[168:171], v14, s[32:35], s61 offen sc1
  v_mfma_f32_32x32x16_bf16 v[96:111], a[120:123], v[188:191], v[96:111]
  v_fma_f32 v195, v195, s70, v34
  v_fma_f32 v196, v196, s70, v34
  v_fma_f32 v197, v197, s70, v34
  v_fma_f32 v198, v198, s70, v34
  v_fma_f32 v199, v199, s70, v34
  v_mul_f32 v192, v192, v64
  v_mul_f32 v193, v193, v65
  s_waitcnt vmcnt(10)
  v_mfma_f32_32x32x16_bf16 v[112:127], a[132:135], v[128:131], v[112:127]
  s_xor_b32 s61, s62, 0x26c00
  buffer_load_dwordx4 v[172:175], v14, s[32:35], s61 offen sc1
  v_mfma_f32_32x32x16_bf16 v[96:111], a[128:131], v[128:131], v[96:111]
  v_mul_f32 v194, v194, v66
  v_mul_f32 v195, v195, v67
  v_mul_f32 v196, v196, v68
  v_mul_f32 v197, v197, v69
  v_mul_f32 v198, v198, v70
  v_mul_f32 v199, v199, v71
  s_waitcnt vmcnt(10)
  v_mfma_f32_32x32x16_bf16 v[112:127], a[140:143], v[132:135], v[112:127]
  s_xor_b32 s61, s62, 0x27000
  buffer_load_dwordx4 v[176:179], v14, s[32:35], s61 offen sc1
  v_mfma_f32_32x32x16_bf16 v[96:111], a[136:139], v[132:135], v[96:111]
  v_exp_f32 v192, v192
  v_exp_f32 v193, v193
  v_exp_f32 v194, v194
  s_waitcnt vmcnt(10)
  v_mfma_f32_32x32x16_bf16 v[112:127], a[148:151], v[136:139], v[112:127]
  s_xor_b32 s61, s62, 0x27400
  buffer_load_dwordx4 v[180:183], v14, s[32:35], s61 offen sc1
  v_mfma_f32_32x32x16_bf16 v[96:111], a[144:147], v[136:139], v[96:111]
  v_exp_f32 v195, v195
  v_exp_f32 v196, v196
  v_exp_f32 v197, v197
  s_waitcnt vmcnt(10)
  v_mfma_f32_32x32x16_bf16 v[112:127], a[156:159], v[140:143], v[112:127]
  s_xor_b32 s61, s62, 0x27800
  buffer_load_dwordx4 v[184:187], v14, s[32:35], s61 offen sc1
  v_mfma_f32_32x32x16_bf16 v[96:111], a[152:155], v[140:143], v[96:111]
  v_exp_f32 v198, v198
  v_exp_f32 v199, v199
  v_add_f32 v192, 1.0, v192
  v_add_f32 v193, 1.0, v193
  v_add_f32 v194, 1.0, v194
  s_waitcnt vmcnt(10)
  v_mfma_f32_32x32x16_bf16 v[112:127], a[164:167], v[144:147], v[112:127]
  s_xor_b32 s61, s62, 0x27c00
  buffer_load_dwordx4 v[188:191], v14, s[32:35], s61 offen sc1
  v_mfma_f32_32x32x16_bf16 v[96:111], a[160:163], v[144:147], v[96:111]
  v_add_f32 v195, 1.0, v195
  v_add_f32 v196, 1.0, v196
  v_add_f32 v197, 1.0, v197
  v_add_f32 v198, 1.0, v198
  v_add_f32 v199, 1.0, v199
  v_rcp_f32 v192, v192
  s_waitcnt vmcnt(10)
  v_mfma_f32_32x32x16_bf16 v[112:127], a[172:175], v[148:151], v[112:127]
  s_lshl_b32 s57, s8, 6
  s_add_u32 m0, s51, 0
  s_add_u32 s57, s57, s16
  buffer_load_dwordx4 v8, s[28:31], s57 offen offset:0 lds
  v_mfma_f32_32x32x16_bf16 v[96:111], a[168:171], v[148:151], v[96:111]
  v_rcp_f32 v193, v193
  v_rcp_f32 v194, v194
  v_rcp_f32 v195, v195
  s_waitcnt vmcnt(10)
  v_mfma_f32_32x32x16_bf16 v[112:127], a[180:183], v[152:155], v[112:127]
  buffer_load_dwordx4 v9, s[28:31], s57 offen offset:1024 lds
  v_mfma_f32_32x32x16_bf16 v[96:111], a[176:179], v[152:155], v[96:111]
  v_rcp_f32 v196, v196
  v_rcp_f32 v197, v197
  v_rcp_f32 v198, v198
  s_waitcnt vmcnt(10)
  v_mfma_f32_32x32x16_bf16 v[112:127], a[188:191], v[156:159], v[112:127]
  buffer_load_dwordx4 v10, s[28:31], s57 offen offset:2048 lds
  v_mfma_f32_32x32x16_bf16 v[96:111], a[184:187], v[156:159], v[96:111]
  v_rcp_f32 v199, v199
  v_mul_f32 v192, v192, v64
  v_mul_f32 v193, v193, v65
  v_mul_f32 v194, v194, v66
  v_mul_f32 v195, v195, v67
  v_mul_f32 v196, v196, v68
  s_waitcnt vmcnt(10)
  v_mfma_f32_32x32x16_bf16 v[112:127], a[196:199], v[160:163], v[112:127]
  buffer_load_dwordx4 v11, s[28:31], s57 offen offset:3072 lds
  v_mfma_f32_32x32x16_bf16 v[96:111], a[192:195], v[160:163], v[96:111]
  v_mul_f32 v197, v197, v69
  v_mul_f32 v198, v198, v70
  v_mul_f32 v199, v199, v71
  v_cvt_pk_bf16_f32 v216, v192, v193
  v_cvt_pk_bf16_f32 v217, v194, v195
  v_cvt_pk_bf16_f32 v218, v196, v197
  v_cvt_pk_bf16_f32 v219, v198, v199
  buffer_store_dwordx4 v[216:219], v14, s[32:35], s63 offen sc1
  s_waitcnt vmcnt(11)
  v_mfma_f32_32x32x16_bf16 v[112:127], a[204:207], v[164:167], v[112:127]
  s_lshl_b32 s57, s8, 6
  s_add_u32 m0, s51, 4096
  s_add_u32 s57, s57, s17
  buffer_load_dwordx4 v8, s[28:31], s57 offen offset:0 lds
  v_mfma_f32_32x32x16_bf16 v[96:111], a[200:203], v[164:167], v[96:111]
  s_waitcnt vmcnt(11)
  v_mfma_f32_32x32x16_bf16 v[112:127], a[212:215], v[168:171], v[112:127]
  buffer_load_dwordx4 v9, s[28:31], s57 offen offset:1024 lds
  v_mfma_f32_32x32x16_bf16 v[96:111], a[208:211], v[168:171], v[96:111]
  s_waitcnt vmcnt(11)
  v_mfma_f32_32x32x16_bf16 v[112:127], a[220:223], v[172:175], v[112:127]
  buffer_load_dwordx4 v10, s[28:31], s57 offen offset:2048 lds
  v_mfma_f32_32x32x16_bf16 v[96:111], a[216:219], v[172:175], v[96:111]
  s_waitcnt vmcnt(11)
  v_mfma_f32_32x32x16_bf16 v[112:127], a[228:231], v[176:179], v[112:127]
  buffer_load_dwordx4 v11, s[28:31], s57 offen offset:3072 lds
  v_mfma_f32_32x32x16_bf16 v[96:111], a[224:227], v[176:179], v[96:111]
  s_waitcnt vmcnt(11)
  v_mfma_f32_32x32x16_bf16 v[112:127], a[236:239], v[180:183], v[112:127]
  v_mfma_f32_32x32x16_bf16 v[96:111], a[232:235], v[180:183], v[96:111]
  s_waitcnt vmcnt(10)
  v_mfma_f32_32x32x16_bf16 v[112:127], a[244:247], v[184:187], v[112:127]
  v_mfma_f32_32x32x16_bf16 v[96:111], a[240:243], v[184:187], v[96:111]
  s_waitcnt vmcnt(9)
  v_mfma_f32_32x32x16_bf16 v[112:127], a[252:255], v[188:191], v[112:127]
  v_mfma_f32_32x32x16_bf16 v[96:111], a[248:251], v[188:191], v[96:111]
  s_nop 8
  s_lshl_b32 s57, s9, 6
  s_add_u32 m0, s51, 8192
  s_add_u32 s57, s57, s16
  buffer_load_dwordx4 v8, s[28:31], s57 offen offset:0 lds
  ds_write_b128 v20, v[120:123] offset:38912
  ds_write_b128 v20, v[124:127] offset:39936
  buffer_load_dwordx4 v9, s[28:31], s57 offen offset:1024 lds
  ds_write_b128 v20, v[112:115] offset:36864
  ds_write_b128 v20, v[116:119] offset:37888
  buffer_load_dwordx4 v10, s[28:31], s57 offen offset:2048 lds
  ds_write_b128 v20, v[104:107] offset:34816
  ds_write_b128 v20, v[108:111] offset:35840
  buffer_load_dwordx4 v11, s[28:31], s57 offen offset:3072 lds
  v_pk_add_f32 v[96:97], v[96:97], v[56:57]
  v_pk_add_f32 v[98:99], v[98:99], v[58:59]
  v_pk_add_f32 v[100:101], v[100:101], v[60:61]
  v_pk_add_f32 v[102:103], v[102:103], v[62:63]
  s_lshl_b32 s57, s9, 6
  s_add_u32 m0, s51, 12288
  s_add_u32 s57, s57, s17
  buffer_load_dwordx4 v8, s[28:31], s57 offen offset:0 lds
  buffer_load_dwordx4 v9, s[28:31], s57 offen offset:1024 lds
  s_waitcnt vmcnt(10)
  buffer_store_dword v50, v48, s[32:35], s100 offen sc1
  buffer_load_dwordx4 v10, s[28:31], s57 offen offset:2048 lds
  buffer_load_dwordx4 v11, s[28:31], s57 offen offset:3072 lds
  s_waitcnt lgkmcnt(0)
  s_barrier
  ds_read_b128 v[192:195], v21 offset:34816
  ds_read_b128 v[196:199], v21 offset:35840
  ds_read_b128 v[200:203], v22 offset:36864
  ds_read_b128 v[204:207], v22 offset:37888
  ds_read_b128 v[208:211], v23 offset:38912
  ds_read_b128 v[212:215], v23 offset:39936
  s_lshl_b32 s57, s10, 6
  s_add_u32 m0, s51, 16384
  s_add_u32 s57, s57, s16
  buffer_load_dwordx4 v8, s[28:31], s57 offen offset:0 lds
  buffer_load_dwordx4 v9, s[28:31], s57 offen offset:1024 lds
  s_waitcnt lgkmcnt(0)
  buffer_load_dwordx4 v10, s[28:31], s57 offen offset:2048 lds
  v_pk_add_f32 v[192:193], v[192:193], v[200:201]
  v_pk_add_f32 v[194:195], v[194:195], v[202:203]
  v_pk_add_f32 v[196:197], v[196:197], v[204:205]
  v_pk_add_f32 v[198:199], v[198:199], v[206:207]
  v_pk_add_f32 v[96:97], v[96:97], v[208:209]
  v_pk_add_f32 v[98:99], v[98:99], v[210:211]
  v_pk_add_f32 v[100:101], v[100:101], v[212:213]
  v_pk_add_f32 v[102:103], v[102:103], v[214:215]
  buffer_load_dwordx4 v11, s[28:31], s57 offen offset:3072 lds
  v_pk_add_f32 v[96:97], v[96:97], v[192:193]
  v_pk_add_f32 v[98:99], v[98:99], v[194:195]
  v_pk_add_f32 v[100:101], v[100:101], v[196:197]
  v_pk_add_f32 v[102:103], v[102:103], v[198:199]
  v_pk_mul_f32 v[192:193], v[96:97], v[96:97]
  v_pk_mul_f32 v[194:195], v[98:99], v[98:99]
  v_pk_mul_f32 v[196:197], v[100:101], v[100:101]
  v_pk_mul_f32 v[198:199], v[102:103], v[102:103]
  ds_read_b64_tr_b16 a[0:1], v16 offset:0
  ds_read_b64_tr_b16 a[2:3], v16 offset:1024
  ds_read_b64_tr_b16 a[4:5], v17 offset:0
  ds_read_b64_tr_b16 a[6:7], v17 offset:1024
  ds_read_b64_tr_b16 a[8:9], v18 offset:0
  ds_read_b64_tr_b16 a[10:11], v18 offset:1024
  ds_read_b64_tr_b16 a[12:13], v19 offset:0
  ds_read_b64_tr_b16 a[14:15], v19 offset:1024
  s_lshl_b32 s57, s10, 6
  s_add_u32 m0, s51, 20480
  s_add_u32 s57, s57, s17
  buffer_load_dwordx4 v8, s[28:31], s57 offen offset:0 lds
  v_pk_fma_f32 v[192:193], v[192:193], s[70:71], v[34:35]
  v_pk_fma_f32 v[194:195], v[194:195], s[70:71], v[34:35]
  v_pk_fma_f32 v[196:197], v[196:197], s[70:71], v[34:35]
  v_pk_fma_f32 v[198:199], v[198:199], s[70:71], v[34:35]
  v_pk_mul_f32 v[192:193], v[192:193], v[96:97]
  v_pk_mul_f32 v[194:195], v[194:195], v[98:99]
  v_pk_mul_f32 v[196:197], v[196:197], v[100:101]
  v_pk_mul_f32 v[198:199], v[198:199], v[102:103]
  buffer_load_dwordx4 v9, s[28:31], s57 offen offset:1024 lds
  v_exp_f32 v192, v192
  v_exp_f32 v193, v193
  v_exp_f32 v194, v194
  v_exp_f32 v195, v195
  v_exp_f32 v196, v196
  v_exp_f32 v197, v197
  v_exp_f32 v198, v198
  v_exp_f32 v199, v199
  buffer_load_dwordx4 v10, s[28:31], s57 offen offset:2048 lds
  v_add_f32 v192, 1.0, v192
  v_add_f32 v193, 1.0, v193
  v_add_f32 v194, 1.0, v194
  v_add_f32 v195, 1.0, v195
  v_add_f32 v196, 1.0, v196
  v_add_f32 v197, 1.0, v197
  v_add_f32 v198, 1.0, v198
  v_add_f32 v199, 1.0, v199
  v_rcp_f32 v192, v192
  v_rcp_f32 v193, v193
  v_rcp_f32 v194, v194
  v_rcp_f32 v195, v195
  buffer_load_dwordx4 v11, s[28:31], s57 offen offset:3072 lds
  v_rcp_f32 v196, v196
  v_rcp_f32 v197, v197
  v_rcp_f32 v198, v198
  v_rcp_f32 v199, v199
  v_pk_mul_f32 v[192:193], v[192:193], v[96:97]
  v_pk_mul_f32 v[194:195], v[194:195], v[98:99]
  v_pk_mul_f32 v[196:197], v[196:197], v[100:101]
  v_pk_mul_f32 v[198:199], v[198:199], v[102:103]
  s_waitcnt vmcnt(17)
  ds_read_b64_tr_b16 a[16:17], v16 offset:4096
  ds_read_b64_tr_b16 a[18:19], v16 offset:5120
  ds_read_b64_tr_b16 a[20:21], v17 offset:4096
  ds_read_b64_tr_b16 a[22:23], v17 offset:5120
  ds_read_b64_tr_b16 a[24:25], v18 offset:4096
  ds_read_b64_tr_b16 a[26:27], v18 offset:5120
  ds_read_b64_tr_b16 a[28:29], v19 offset:4096
  ds_read_b64_tr_b16 a[30:31], v19 offset:5120
  s_lshl_b32 s57, s11, 6
  s_add_u32 m0, s51, 24576
  s_add_u32 s57, s57, s16
  buffer_load_dwordx4 v8, s[28:31], s57 offen offset:0 lds
  v_cvt_pk_bf16_f32 v216, v192, v193
  v_cvt_pk_bf16_f32 v217, v194, v195
  v_cvt_pk_bf16_f32 v218, v196, v197
  v_cvt_pk_bf16_f32 v219, v198, v199
  s_add_u32 s63, s63, 114688
  buffer_store_dwordx4 v[216:219], v14, s[32:35], s63 offen sc1
  buffer_load_dwordx4 v9, s[28:31], s57 offen offset:1024 lds
  buffer_load_dwordx4 v10, s[28:31], s57 offen offset:2048 lds
  buffer_load_dwordx4 v11, s[28:31], s57 offen offset:3072 lds
  s_waitcnt vmcnt(18)
  ds_read_b64_tr_b16 a[32:33], v16 offset:8192
  ds_read_b64_tr_b16 a[34:35], v16 offset:9216
  ds_read_b64_tr_b16 a[36:37], v17 offset:8192
  ds_read_b64_tr_b16 a[38:39], v17 offset:9216
  ds_read_b64_tr_b16 a[40:41], v18 offset:8192
  ds_read_b64_tr_b16 a[42:43], v18 offset:9216
  ds_read_b64_tr_b16 a[44:45], v19 offset:8192
  ds_read_b64_tr_b16 a[46:47], v19 offset:9216
  s_waitcnt lgkmcnt(0)
  s_lshl_b32 s57, s11, 6
  s_add_u32 m0, s51, 0
  s_add_u32 s57, s57, s17
  buffer_load_dwordx4 v8, s[28:31], s57 offen offset:0 lds
  buffer_load_dwordx4 v9, s[28:31], s57 offen offset:1024 lds
  buffer_load_dwordx4 v10, s[28:31], s57 offen offset:2048 lds
  buffer_load_dwordx4 v11, s[28:31], s57 offen offset:3072 lds
  s_waitcnt vmcnt(17)
  ds_read_b64_tr_b16 a[48:49], v16 offset:12288
  ds_read_b64_tr_b16 a[50:51], v16 offset:13312
  ds_read_b64_tr_b16 a[52:53], v17 offset:12288
  ds_read_b64_tr_b16 a[54:55], v17 offset:13312
  ds_read_b64_tr_b16 a[56:57], v18 offset:12288
  ds_read_b64_tr_b16 a[58:59], v18 offset:13312
  ds_read_b64_tr_b16 a[60:61], v19 offset:12288
  ds_read_b64_tr_b16 a[62:63], v19 offset:13312
  s_lshl_b32 s57, s12, 6
  s_add_u32 m0, s51, 4096
  s_add_u32 s57, s57, s16
  buffer_load_dwordx4 v8, s[28:31], s57 offen offset:0 lds
  buffer_load_dwordx4 v9, s[28:31], s57 offen offset:1024 lds
  buffer_load_dwordx4 v10, s[28:31], s57 offen offset:2048 lds
  buffer_load_dwordx4 v11, s[28:31], s57 offen offset:3072 lds
  s_waitcnt vmcnt(17)
  ds_read_b64_tr_b16 a[64:65], v16 offset:16384
  ds_read_b64_tr_b16 a[66:67], v16 offset:17408
  ds_read_b64_tr_b16 a[68:69], v17 offset:16384
  ds_read_b64_tr_b16 a[70:71], v17 offset:17408
  ds_read_b64_tr_b16 a[72:73], v18 offset:16384
  ds_read_b64_tr_b16 a[74:75], v18 offset:17408
  ds_read_b64_tr_b16 a[76:77], v19 offset:16384
  ds_read_b64_tr_b16 a[78:79], v19 offset:17408
  s_lshl_b32 s57, s12, 6
  s_add_u32 m0, s51, 8192
  s_add_u32 s57, s57, s17
  buffer_load_dwordx4 v8, s[28:31], s57 offen offset:0 lds
  s_waitcnt vmcnt(12)
  s_add_u32 s100, s100, 100352
  buffer_store_dword v50, v48, s[32:35], s100 offen sc1
  buffer_load_dwordx4 v9, s[28:31], s57 offen offset:1024 lds
  buffer_load_dwordx4 v10, s[28:31], s57 offen offset:2048 lds
  buffer_load_dwordx4 v11, s[28:31], s57 offen offset:3072 lds
  ds_read_b64_tr_b16 a[80:81], v16 offset:20480
  ds_read_b64_tr_b16 a[82:83], v16 offset:21504
  ds_read_b64_tr_b16 a[84:85], v17 offset:20480
  ds_read_b64_tr_b16 a[86:87], v17 offset:21504
  ds_read_b64_tr_b16 a[88:89], v18 offset:20480
  ds_read_b64_tr_b16 a[90:91], v18 offset:21504
  ds_read_b64_tr_b16 a[92:93], v19 offset:20480
  ds_read_b64_tr_b16 a[94:95], v19 offset:21504
  s_bitcmp1_b32 s64, 1
  s_cbranch_scc0 L_fin
  buffer_load_dword v33, v39, s[32:35], s101 offen sc1
  s_waitcnt lgkmcnt(0)
  s_lshl_b32 s57, s13, 6
  s_add_u32 m0, s51, 12288
  s_add_u32 s57, s57, s16
  buffer_load_dwordx4 v8, s[28:31], s57 offen offset:0 lds
  buffer_load_dwordx4 v9, s[28:31], s57 offen offset:1024 lds
  buffer_load_dwordx4 v10, s[28:31], s57 offen offset:2048 lds
  buffer_load_dwordx4 v11, s[28:31], s57 offen offset:3072 lds
  s_waitcnt vmcnt(18)
  ds_read_b64_tr_b16 a[96:97], v16 offset:24576
  ds_read_b64_tr_b16 a[98:99], v16 offset:25600
  ds_read_b64_tr_b16 a[100:101], v17 offset:24576
  ds_read_b64_tr_b16 a[102:103], v17 offset:25600
  ds_read_b64_tr_b16 a[104:105], v18 offset:24576
  ds_read_b64_tr_b16 a[106:107], v18 offset:25600
  ds_read_b64_tr_b16 a[108:109], v19 offset:24576
  ds_read_b64_tr_b16 a[110:111], v19 offset:25600
  s_lshl_b32 s57, s13, 6
  s_add_u32 m0, s51, 16384
  s_add_u32 s57, s57, s17
  buffer_load_dwordx4 v8, s[28:31], s57 offen offset:0 lds
  buffer_load_dwordx4 v9, s[28:31], s57 offen offset:1024 lds
  buffer_load_dwordx4 v10, s[28:31], s57 offen offset:2048 lds
  buffer_load_dwordx4 v11, s[28:31], s57 offen offset:3072 lds
  s_waitcnt vmcnt(18)
  ds_read_b64_tr_b16 a[112:113], v16 offset:0
  ds_read_b64_tr_b16 a[114:115], v16 offset:1024
  ds_read_b64_tr_b16 a[116:117], v17 offset:0
  ds_read_b64_tr_b16 a[118:119], v17 offset:1024
  ds_read_b64_tr_b16 a[120:121], v18 offset:0
  ds_read_b64_tr_b16 a[122:123], v18 offset:1024
  ds_read_b64_tr_b16 a[124:125], v19 offset:0
  ds_read_b64_tr_b16 a[126:127], v19 offset:1024
  s_lshl_b32 s57, s14, 6
  s_add_u32 m0, s51, 20480
  s_add_u32 s57, s57, s16
  buffer_load_dwordx4 v8, s[28:31], s57 offen offset:0 lds
  buffer_load_dwordx4 v9, s[28:31], s57 offen offset:1024 lds
  buffer_load_dwordx4 v10, s[28:31], s57 offen offset:2048 lds
  buffer_load_dwordx4 v11, s[28:31], s57 offen offset:3072 lds
  s_waitcnt vmcnt(18)
  ds_read_b64_tr_b16 a[128:129], v16 offset:4096
  ds_read_b64_tr_b16 a[130:131], v16 offset:5120
  ds_read_b64_tr_b16 a[132:133], v17 offset:4096
  ds_read_b64_tr_b16 a[134:135], v17 offset:5120
  ds_read_b64_tr_b16 a[136:137], v18 offset:4096
  ds_read_b64_tr_b16 a[138:139], v18 offset:5120
  ds_read_b64_tr_b16 a[140:141], v19 offset:4096
  ds_read_b64_tr_b16 a[142:143], v19 offset:5120
  s_waitcnt lgkmcnt(0)
  s_lshl_b32 s57, s14, 6
  s_add_u32 m0, s51, 24576
  s_add_u32 s57, s57, s17
  buffer_load_dwordx4 v8, s[28:31], s57 offen offset:0 lds
  buffer_load_dwordx4 v9, s[28:31], s57 offen offset:1024 lds
  buffer_load_dwordx4 v10, s[28:31], s57 offen offset:2048 lds
  buffer_load_dwordx4 v11, s[28:31], s57 offen offset:3072 lds
  s_waitcnt vmcnt(17)
  ds_read_b64_tr_b16 a[144:145], v16 offset:8192
  ds_read_b64_tr_b16 a[146:147], v16 offset:9216
  ds_read_b64_tr_b16 a[148:149], v17 offset:8192
  ds_read_b64_tr_b16 a[150:151], v17 offset:9216
  ds_read_b64_tr_b16 a[152:153], v18 offset:8192
  ds_read_b64_tr_b16 a[154:155], v18 offset:9216
  ds_read_b64_tr_b16 a[156:157], v19 offset:8192
  ds_read_b64_tr_b16 a[158:159], v19 offset:9216
  s_waitcnt vmcnt(16)
  v_cmp_ne_u32 vcc, s52, v33
  s_cbranch_vccz L_p2_ok
L_p2_loop:
  buffer_load_dword v33, v39, s[32:35], s101 offen sc1
  s_add_u32 s65, s65, 1
  s_cmp_ge_u32 s65, 0x20000
  s_cbranch_scc1 L_p2_ok
  s_waitcnt vmcnt(0)
  v_cmp_ne_u32 vcc, s52, v33
  s_cbranch_vccz L_p2_ok
  s_sleep 4
  s_branch L_p2_loop
L_roleC:
  s_mov_b32 s24, s28
  s_mov_b32 s25, s29
  s_cmp_eq_u32 s54, 7
  s_cselect_b32 s26, 0x700000, 0
  s_mov_b32 s67, s23
  s_mov_b32 s65, 0
  s_add_u32 m0, s51, 8192
  buffer_load_dwordx2 v[24:25], v36, s[40:43], s0 offen offset:0
  buffer_load_dwordx2 v[26:27], v36, s[40:43], s0 offen offset:16
  buffer_load_ushort v32, v37, s[44:47], s1 offen
  s_mov_b32 s66, s67
  buffer_load_dwordx4 v8, s[24:27], s66 offen offset:0 lds
  buffer_load_dwordx4 v9, s[24:27], s66 offen offset:1024 lds
  buffer_load_dwordx4 v10, s[24:27], s66 offen offset:2048 lds
  buffer_load_dwordx4 v11, s[24:27], s66 offen offset:3072 lds
  s_add_u32 s67, s67, 131072
  s_add_u32 s65, s65, 1
  s_mov_b32 s66, s67
  buffer_load_dwordx4 v8, s[24:27], s66 offen offset:0 lds
  buffer_load_dwordx4 v9, s[24:27], s66 offen offset:1024 lds
  buffer_load_dwordx4 v10, s[24:27], s66 offen offset:2048 lds
  buffer_load_dwordx4 v11, s[24:27], s66 offen offset:3072 lds
  s_add_u32 s67, s67, 131072
  s_add_u32 s65, s65, 1
  s_waitcnt vmcnt(11)
  buffer_store_dword v50, v44, s[32:35], s22 offen sc1
  s_cmp_eq_u32 s64, 0
  s_cbranch_scc1 L_fin
  s_cmp_lg_u32 s54, 7
  s_cbranch_scc1 L_cp_done
L_cp_loop:
  s_mov_b32 s66, s67
  buffer_load_dwordx4 v8, s[24:27], s66 offen offset:0 lds
  buffer_load_dwordx4 v9, s[24:27], s66 offen offset:1024 lds
  buffer_load_dwordx4 v10, s[24:27], s66 offen offset:2048 lds
  buffer_load_dwordx4 v11, s[24:27], s66 offen offset:3072 lds
  s_add_u32 s67, s67, 131072
  s_add_u32 s65, s65, 1
  s_cmp_lt_u32 s65, 14
  s_cbranch_scc1 L_cp_loop
L_cp_done:
  s_waitcnt vmcnt(0)
  v_lshlrev_b32 v32, 16, v32
  s_lshl_b32 s57, s8, 6
  s_add_u32 m0, s51, 0
  s_add_u32 s57, s57, s16
  buffer_load_dwordx4 v8, s[28:31], s57 offen offset:0 lds
  buffer_load_dwordx4 v9, s[28:31], s57 offen offset:1024 lds
  buffer_load_dwordx4 v10, s[28:31], s57 offen offset:2048 lds
  buffer_load_dwordx4 v11, s[28:31], s57 offen offset:3072 lds
  s_lshl_b32 s57, s8, 6
  s_add_u32 m0, s51, 4096
  s_add_u32 s57, s57, s17
  buffer_load_dwordx4 v8, s[28:31], s57 offen offset:0 lds
  buffer_load_dwordx4 v9, s[28:31], s57 offen offset:1024 lds
  buffer_load_dwordx4 v10, s[28:31], s57 offen offset:2048 lds
  buffer_load_dwordx4 v11, s[28:31], s57 offen offset:3072 lds
  s_lshl_b32 s57, s9, 6
  s_add_u32 m0, s51, 8192
  s_add_u32 s57, s57, s16
  buffer_load_dwordx4 v8, s[28:31], s57 offen offset:0 lds
  buffer_load_dwordx4 v9, s[28:31], s57 offen offset:1024 lds
  buffer_load_dwordx4 v10, s[28:31], s57 offen offset:2048 lds
  buffer_load_dwordx4 v11, s[28:31], s57 offen offset:3072 lds
  s_lshl_b32 s57, s9, 6
  s_add_u32 m0, s51, 12288
  s_add_u32 s57, s57, s17
  buffer_load_dwordx4 v8, s[28:31], s57 offen offset:0 lds
  buffer_load_dwordx4 v9, s[28:31], s57 offen offset:1024 lds
  buffer_load_dwordx4 v10, s[28:31], s57 offen offset:2048 lds
  buffer_load_dwordx4 v11, s[28:31], s57 offen offset:3072 lds
  s_lshl_b32 s57, s10, 6
  s_add_u32 m0, s51, 16384
  s_add_u32 s57, s57, s16
  buffer_load_dwordx4 v8, s[28:31], s57 offen offset:0 lds
  buffer_load_dwordx4 v9, s[28:31], s57 offen offset:1024 lds
  buffer_load_dwordx4 v10, s[28:31], s57 offen offset:2048 lds
  buffer_load_dwordx4 v11, s[28:31], s57 offen offset:3072 lds
  s_waitcnt vmcnt(16)
  ds_read_b64_tr_b16 a[0:1], v16 offset:0
  ds_read_b64_tr_b16 a[2:3], v16 offset:1024
  ds_read_b64_tr_b16 a[4:5], v17 offset:0
  ds_read_b64_tr_b16 a[6:7], v17 offset:1024
  ds_read_b64_tr_b16 a[8:9], v18 offset:0
  ds_read_b64_tr_b16 a[10:11], v18 offset:1024
  ds_read_b64_tr_b16 a[12:13], v19 offset:0
  ds_read_b64_tr_b16 a[14:15], v19 offset:1024
  s_lshl_b32 s57, s10, 6
  s_add_u32 m0, s51, 20480
  s_add_u32 s57, s57, s17
  buffer_load_dwordx4 v8, s[28:31], s57 offen offset:0 lds
  buffer_load_dwordx4 v9, s[28:31], s57 offen offset:1024 lds
  buffer_load_dwordx4 v10, s[28:31], s57 offen offset:2048 lds
  buffer_load_dwordx4 v11, s[28:31], s57 offen offset:3072 lds
  s_waitcnt vmcnt(16)
  ds_read_b64_tr_b16 a[16:17], v16 offset:4096
  ds_read_b64_tr_b16 a[18:19], v16 offset:5120
  ds_read_b64_tr_b16 a[20:21], v17 offset:4096
  ds_read_b64_tr_b16 a[22:23], v17 offset:5120
  ds_read_b64_tr_b16 a[24:25], v18 offset:4096
  ds_read_b64_tr_b16 a[26:27], v18 offset:5120
  ds_read_b64_tr_b16 a[28:29], v19 offset:4096
  ds_read_b64_tr_b16 a[30:31], v19 offset:5120
  s_lshl_b32 s57, s11, 6
  s_add_u32 m0, s51, 24576
  s_add_u32 s57, s57, s16
  buffer_load_dwordx4 v8, s[28:31], s57 offen offset:0 lds
  buffer_load_dwordx4 v9, s[28:31], s57 offen offset:1024 lds
  buffer_load_dwordx4 v10, s[28:31], s57 offen offset:2048 lds
  buffer_load_dwordx4 v11, s[28:31], s57 offen offset:3072 lds
  s_waitcnt vmcnt(16)
  ds_read_b64_tr_b16 a[32:33], v16 offset:8192
  ds_read_b64_tr_b16 a[34:35], v16 offset:9216
  ds_read_b64_tr_b16 a[36:37], v17 offset:8192
  ds_read_b64_tr_b16 a[38:39], v17 offset:9216
  ds_read_b64_tr_b16 a[40:41], v18 offset:8192
  ds_read_b64_tr_b16 a[42:43], v18 offset:9216
  ds_read_b64_tr_b16 a[44:45], v19 offset:8192
  ds_read_b64_tr_b16 a[46:47], v19 offset:9216
  s_waitcnt lgkmcnt(0)
  s_lshl_b32 s57, s11, 6
  s_add_u32 m0, s51, 0
  s_add_u32 s57, s57, s17
  buffer_load_dwordx4 v8, s[28:31], s57 offen offset:0 lds
  buffer_load_dwordx4 v9, s[28:31], s57 offen offset:1024 lds
  buffer_load_dwordx4 v10, s[28:31], s57 offen offset:2048 lds
  buffer_load_dwordx4 v11, s[28:31], s57 offen offset:3072 lds
  s_waitcnt vmcnt(16)
  ds_read_b64_tr_b16 a[48:49], v16 offset:12288
  ds_read_b64_tr_b16 a[50:51], v16 offset:13312
  ds_read_b64_tr_b16 a[52:53], v17 offset:12288
  ds_read_b64_tr_b16 a[54:55], v17 offset:13312
  ds_read_b64_tr_b16 a[56:57], v18 offset:12288
  ds_read_b64_tr_b16 a[58:59], v18 offset:13312
  ds_read_b64_tr_b16 a[60:61], v19 offset:12288
  ds_read_b64_tr_b16 a[62:63], v19 offset:13312
  s_lshl_b32 s57, s12, 6
  s_add_u32 m0, s51, 4096
  s_add_u32 s57, s57, s16
  buffer_load_dwordx4 v8, s[28:31], s57 offen offset:0 lds
  buffer_load_dwordx4 v9, s[28:31], s57 offen offset:1024 lds
  buffer_load_dwordx4 v10, s[28:31], s57 offen offset:2048 lds
  buffer_load_dwordx4 v11, s[28:31], s57 offen offset:3072 lds
  s_waitcnt vmcnt(16)
  ds_read_b64_tr_b16 a[64:65], v16 offset:16384
  ds_read_b64_tr_b16 a[66:67], v16 offset:17408
  ds_read_b64_tr_b16 a[68:69], v17 offset:16384
  ds_read_b64_tr_b16 a[70:71], v17 offset:17408
  ds_read_b64_tr_b16 a[72:73], v18 offset:16384
  ds_read_b64_tr_b16 a[74:75], v18 offset:17408
  ds_read_b64_tr_b16 a[76:77], v19 offset:16384
  ds_read_b64_tr_b16 a[78:79], v19 offset:17408
  s_lshl_b32 s57, s12, 6
  s_add_u32 m0, s51, 8192
  s_add_u32 s57, s57, s17
  buffer_load_dwordx4 v8, s[28:31], s57 offen offset:0 lds
  buffer_load_dwordx4 v9, s[28:31], s57 offen offset:1024 lds
  buffer_load_dwordx4 v10, s[28:31], s57 offen offset:2048 lds
  buffer_load_dwordx4 v11, s[28:31], s57 offen offset:3072 lds
  s_waitcnt vmcnt(16)
  ds_read_b64_tr_b16 a[80:81], v16 offset:20480
  ds_read_b64_tr_b16 a[82:83], v16 offset:21504
  ds_read_b64_tr_b16 a[84:85], v17 offset:20480
  ds_read_b64_tr_b16 a[86:87], v17 offset:21504
  ds_read_b64_tr_b16 a[88:89], v18 offset:20480
  ds_read_b64_tr_b16 a[90:91], v18 offset:21504
  ds_read_b64_tr_b16 a[92:93], v19 offset:20480
  ds_read_b64_tr_b16 a[94:95], v19 offset:21504
  s_waitcnt lgkmcnt(0)
  s_lshl_b32 s57, s13, 6
  s_add_u32 m0, s51, 12288
  s_add_u32 s57, s57, s16
  buffer_load_dwordx4 v8, s[28:31], s57 offen offset:0 lds
  buffer_load_dwordx4 v9, s[28:31], s57 offen offset:1024 lds
  buffer_load_dwordx4 v10, s[28:31], s57 offen offset:2048 lds
  buffer_load_dwordx4 v11, s[28:31], s57 offen offset:3072 lds
  s_waitcnt vmcnt(16)
  ds_read_b64_tr_b16 a[96:97], v16 offset:24576
  ds_read_b64_tr_b16 a[98:99], v16 offset:25600
  ds_read_b64_tr_b16 a[100:101], v17 offset:24576
  ds_read_b64_tr_b16 a[102:103], v17 offset:25600
  ds_read_b64_tr_b16 a[104:105], v18 offset:24576
  ds_read_b64_tr_b16 a[106:107], v18 offset:25600
  ds_read_b64_tr_b16 a[108:109], v19 offset:24576
  ds_read_b64_tr_b16 a[110:111], v19 offset:25600
  s_lshl_b32 s57, s13, 6
  s_add_u32 m0, s51, 16384
  s_add_u32 s57, s57, s17
  buffer_load_dwordx4 v8, s[28:31], s57 offen offset:0 lds
  buffer_load_dwordx4 v9, s[28:31], s57 offen offset:1024 lds
  buffer_load_dwordx4 v10, s[28:31], s57 offen offset:2048 lds
  buffer_load_dwordx4 v11, s[28:31], s57 offen offset:3072 lds
  s_waitcnt vmcnt(16)
  ds_read_b64_tr_b16 a[112:113], v16 offset:0
  ds_read_b64_tr_b16 a[114:115], v16 offset:1024
  ds_read_b64_tr_b16 a[116:117], v17 offset:0
  ds_read_b64_tr_b16 a[118:119], v17 offset:1024
  ds_read_b64_tr_b16 a[120:121], v18 offset:0
  ds_read_b64_tr_b16 a[122:123], v18 offset:1024
  ds_read_b64_tr_b16 a[124:125], v19 offset:0
  ds_read_b64_tr_b16 a[126:127], v19 offset:1024
  s_lshl_b32 s57, s14, 6
  s_add_u32 m0, s51, 20480
  s_add_u32 s57, s57, s16
  buffer_load_dwordx4 v8, s[28:31], s57 offen offset:0 lds
  buffer_load_dwordx4 v9, s[28:31], s57 offen offset:1024 lds
  buffer_load_dwordx4 v10, s[28:31], s57 offen offset:2048 lds
  buffer_load_dwordx4 v11, s[28:31], s57 offen offset:3072 lds
  s_waitcnt vmcnt(16)
  ds_read_b64_tr_b16 a[128:129], v16 offset:4096
  ds_read_b64_tr_b16 a[130:131], v16 offset:5120
  ds_read_b64_tr_b16 a[132:133], v17 offset:4096
  ds_read_b64_tr_b16 a[134:135], v17 offset:5120
  ds_read_b64_tr_b16 a[136:137], v18 offset:4096
  ds_read_b64_tr_b16 a[138:139], v18 offset:5120
  ds_read_b64_tr_b16 a[140:141], v19 offset:4096
  ds_read_b64_tr_b16 a[142:143], v19 offset:5120
  s_waitcnt lgkmcnt(0)
  s_lshl_b32 s57, s14, 6
  s_add_u32 m0, s51, 24576
  s_add_u32 s57, s57, s17
  buffer_load_dwordx4 v8, s[28:31], s57 offen offset:0 lds
  buffer_load_dwordx4 v9, s[28:31], s57 offen offset:1024 lds
  buffer_load_dwordx4 v10, s[28:31], s57 offen offset:2048 lds
  buffer_load_dwordx4 v11, s[28:31], s57 offen offset:3072 lds
  s_waitcnt vmcnt(16)
  ds_read_b64_tr_b16 a[144:145], v16 offset:8192
  ds_read_b64_tr_b16 a[146:147], v16 offset:9216
  ds_read_b64_tr_b16 a[148:149], v17 offset:8192
  ds_read_b64_tr_b16 a[150:151], v17 offset:9216
  ds_read_b64_tr_b16 a[152:153], v18 offset:8192
  ds_read_b64_tr_b16 a[154:155], v18 offset:9216
  ds_read_b64_tr_b16 a[156:157], v19 offset:8192
  ds_read_b64_tr_b16 a[158:159], v19 offset:9216
  s_mov_b32 s65, 0
L_p2c_loop:
  buffer_load_dword v33, v39, s[32:35], s101 offen sc1
  s_add_u32 s65, s65, 1
  s_cmp_ge_u32 s65, 0x20000
  s_cbranch_scc1 L_p2_ok
  s_waitcnt vmcnt(0)
  v_cmp_ne_u32 vcc, s52, v33
  s_cbranch_vccz L_p2_ok
  s_sleep 10
  s_branch L_p2c_loop
L_p2_ok:
  s_add_u32 s61, s4, s8
  buffer_load_dwordx4 v[128:131], v12, s[32:35], s61 offen sc1
  s_add_u32 s61, s5, s8
  buffer_load_dwordx4 v[132:135], v12, s[32:35], s61 offen sc1
  s_add_u32 s61, s6, s8
  buffer_load_dwordx4 v[136:139], v12, s[32:35], s61 offen sc1
  s_waitcnt vmcnt(15)
  ds_read_b64_tr_b16 a[160:161], v16 offset:12288
  ds_read_b64_tr_b16 a[162:163], v16 offset:13312
  ds_read_b64_tr_b16 a[164:165], v17 offset:12288
  ds_read_b64_tr_b16 a[166:167], v17 offset:13312
  ds_read_b64_tr_b16 a[168:169], v18 offset:12288
  ds_read_b64_tr_b16 a[170:171], v18 offset:13312
  ds_read_b64_tr_b16 a[172:173], v19 offset:12288
  ds_read_b64_tr_b16 a[174:175], v19 offset:13312
  s_add_u32 s61, s7, s8
  buffer_load_dwordx4 v[140:143], v12, s[32:35], s61 offen sc1
  s_add_u32 s61, s4, s9
  buffer_load_dwordx4 v[144:147], v12, s[32:35], s61 offen sc1
  s_add_u32 s61, s5, s9
  buffer_load_dwordx4 v[148:151], v12, s[32:35], s61 offen sc1
  s_waitcnt vmcnt(14)
  ds_read_b64_tr_b16 a[176:177], v16 offset:16384
  ds_read_b64_tr_b16 a[178:179], v16 offset:17408
  ds_read_b64_tr_b16 a[180:181], v17 offset:16384
  ds_read_b64_tr_b16 a[182:183], v17 offset:17408
  ds_read_b64_tr_b16 a[184:185], v18 offset:16384
  ds_read_b64_tr_b16 a[186:187], v18 offset:17408
  ds_read_b64_tr_b16 a[188:189], v19 offset:16384
  ds_read_b64_tr_b16 a[190:191], v19 offset:17408
  s_add_u32 s61, s6, s9
  buffer_load_dwordx4 v[152:155], v12, s[32:35], s61 offen sc1
  s_add_u32 s61, s7, s9
  buffer_load_dwordx4 v[156:159], v12, s[32:35], s61 offen sc1
  s_add_u32 s61, s4, s10
  buffer_load_dwordx4 v[160:163], v12, s[32:35], s61 offen sc1
  s_waitcnt vmcnt(13)
  ds_read_b64_tr_b16 a[192:193], v16 offset:20480
  ds_read_b64_tr_b16 a[194:195], v16 offset:21504
  ds_read_b64_tr_b16 a[196:197], v17 offset:20480
  ds_read_b64_tr_b16 a[198:199], v17 offset:21504
  ds_read_b64_tr_b16 a[200:201], v18 offset:20480
  ds_read_b64_tr_b16 a[202:203], v18 offset:21504
  ds_read_b64_tr_b16 a[204:205], v19 offset:20480
  ds_read_b64_tr_b16 a[206:207], v19 offset:21504
  s_add_u32 s61, s5, s10
  buffer_load_dwordx4 v[164:167], v12, s[32:35], s61 offen sc1
  s_add_u32 s61, s6, s10
  buffer_load_dwordx4 v[168:171], v12, s[32:35], s61 offen sc1
  s_waitcnt vmcnt(11)
  ds_read_b64_tr_b16 a[208:209], v16 offset:24576
  ds_read_b64_tr_b16 a[210:211], v16 offset:25600
  ds_read_b64_tr_b16 a[212:213], v17 offset:24576
  ds_read_b64_tr_b16 a[214:215], v17 offset:25600
  ds_read_b64_tr_b16 a[216:217], v18 offset:24576
  ds_read_b64_tr_b16 a[218:219], v18 offset:25600
  ds_read_b64_tr_b16 a[220:221], v19 offset:24576
  ds_read_b64_tr_b16 a[222:223], v19 offset:25600
  s_waitcnt lgkmcnt(0)
  s_waitcnt vmcnt(10)
  v_mfma_f32_32x32x16_bf16 v[80:95], v[128:131], a[4:7], 0
  s_add_u32 s61, s7, s10
  buffer_load_dwordx4 v[172:175], v12, s[32:35], s61 offen sc1
  v_mfma_f32_32x32x16_bf16 v[64:79], v[128:131], a[0:3], 0
  s_waitcnt vmcnt(10)
  v_mfma_f32_32x32x16_bf16 v[80:95], v[132:135], a[12:15], v[80:95]
  s_add_u32 s61, s4, s11
  buffer_load_dwordx4 v[176:179], v12, s[32:35], s61 offen sc1
  v_mfma_f32_32x32x16_bf16 v[64:79], v[132:135], a[8:11], v[64:79]
  s_waitcnt vmcnt(10)
  v_mfma_f32_32x32x16_bf16 v[80:95], v[136:139], a[20:23], v[80:95]
  s_add_u32 s61, s5, s11
  buffer_load_dwordx4 v[180:183], v12, s[32:35], s61 offen sc1
  v_mfma_f32_32x32x16_bf16 v[64:79], v[136:139], a[16:19], v[64:79]
  s_waitcnt vmcnt(10)
  v_mfma_f32_32x32x16_bf16 v[80:95], v[140:143], a[28:31], v[80:95]
  s_add_u32 s61, s6, s11
  buffer_load_dwordx4 v[184:187], v12, s[32:35], s61 offen sc1
  v_mfma_f32_32x32x16_bf16 v[64:79], v[140:143], a[24:27], v[64:79]
  s_waitcnt vmcnt(10)
  v_mfma_f32_32x32x16_bf16 v[80:95], v[144:147], a[36:39], v[80:95]
  s_add_u32 s61, s7, s11
  buffer_load_dwordx4 v[188:191], v12, s[32:35], s61 offen sc1
  v_mfma_f32_32x32x16_bf16 v[64:79], v[144:147], a[32:35], v[64:79]
  s_waitcnt vmcnt(10)
  v_mfma_f32_32x32x16_bf16 v[80:95], v[148:151], a[44:47], v[80:95]
  s_add_u32 s101, s101, 100352
  buffer_load_dword v33, v39, s[32:35], s101 offen sc1
  s_add_u32 s61, s4, s12
  buffer_load_dwordx4 v[128:131], v12, s[32:35], s61 offen sc1
  v_mfma_f32_32x32x16_bf16 v[64:79], v[148:151], a[40:43], v[64:79]
  s_waitcnt vmcnt(11)
  v_mfma_f32_32x32x16_bf16 v[80:95], v[152:155], a[52:55], v[80:95]
  s_add_u32 s61, s5, s12
  buffer_load_dwordx4 v[132:135], v12, s[32:35], s61 offen sc1
  v_mfma_f32_32x32x16_bf16 v[64:79], v[152:155], a[48:51], v[64:79]
  s_waitcnt vmcnt(11)
  v_mfma_f32_32x32x16_bf16 v[80:95], v[156:159], a[60:63], v[80:95]
  s_add_u32 s61, s6, s12
  buffer_load_dwordx4 v[136:139], v12, s[32:35], s61 offen sc1
  v_mfma_f32_32x32x16_bf16 v[64:79], v[156:159], a[56:59], v[64:79]
  s_waitcnt vmcnt(11)
  v_mfma_f32_32x32x16_bf16 v[80:95], v[160:163], a[68:71], v[80:95]
  s_add_u32 s61, s7, s12
  buffer_load_dwordx4 v[140:143], v12, s[32:35], s61 offen sc1
  v_mfma_f32_32x32x16_bf16 v[64:79], v[160:163], a[64:67], v[64:79]
  s_waitcnt vmcnt(11)
  v_mfma_f32_32x32x16_bf16 v[80:95], v[164:167], a[76:79], v[80:95]
  s_add_u32 s61, s4, s13
  buffer_load_dwordx4 v[144:147], v12, s[32:35], s61 offen sc1
  v_mfma_f32_32x32x16_bf16 v[64:79], v[164:167], a[72:75], v[64:79]
  s_waitcnt vmcnt(11)
  v_mfma_f32_32x32x16_bf16 v[80:95], v[168:171], a[84:87], v[80:95]
  s_add_u32 s61, s5, s13
  buffer_load_dwordx4 v[148:151], v12, s[32:35], s61 offen sc1
  v_mfma_f32_32x32x16_bf16 v[64:79], v[168:171], a[80:83], v[64:79]
  s_waitcnt vmcnt(11)
  v_mfma_f32_32x32x16_bf16 v[80:95], v[172:175], a[92:95], v[80:95]
  s_add_u32 s61, s6, s13
  buffer_load_dwordx4 v[152:155], v12, s[32:35], s61 offen sc1
  v_mfma_f32_32x32x16_bf16 v[64:79], v[172:175], a[88:91], v[64:79]
  s_waitcnt vmcnt(11)
  v_mfma_f32_32x32x16_bf16 v[80:95], v[176:179], a[100:103], v[80:95]
  s_add_u32 s61, s7, s13
  buffer_load_dwordx4 v[156:159], v12, s[32:35], s61 offen sc1
  v_mfma_f32_32x32x16_bf16 v[64:79], v[176:179], a[96:99], v[64:79]
  s_waitcnt vmcnt(11)
  v_mfma_f32_32x32x16_bf16 v[80:95], v[180:183], a[108:111], v[80:95]
  s_add_u32 s61, s4, s14
  buffer_load_dwordx4 v[160:163], v12, s[32:35], s61 offen sc1
  v_mfma_f32_32x32x16_bf16 v[64:79], v[180:183], a[104:107], v[64:79]
  s_waitcnt vmcnt(11)
  v_mfma_f32_32x32x16_bf16 v[80:95], v[184:187], a[116:119], v[80:95]
  s_add_u32 s61, s5, s14
  buffer_load_dwordx4 v[164:167], v12, s[32:35], s61 offen sc1
  v_mfma_f32_32x32x16_bf16 v[64:79], v[184:187], a[112:115], v[64:79]
  s_waitcnt vmcnt(11)
  v_mfma_f32_32x32x16_bf16 v[80:95], v[188:191], a[124:127], v[80:95]
  s_add_u32 s61, s6, s14
  buffer_load_dwordx4 v[168:171], v12, s[32:35], s61 offen sc1
  v_mfma_f32_32x32x16_bf16 v[64:79], v[188:191], a[120:123], v[64:79]
  s_waitcnt vmcnt(10)
  v_mfma_f32_32x32x16_bf16 v[80:95], v[128:131], a[132:135], v[80:95]
  s_add_u32 s61, s7, s14
  buffer_load_dwordx4 v[172:175], v12, s[32:35], s61 offen sc1
  v_mfma_f32_32x32x16_bf16 v[64:79], v[128:131], a[128:131], v[64:79]
  s_waitcnt vmcnt(10)
  v_mfma_f32_32x32x16_bf16 v[80:95], v[132:135], a[140:143], v[80:95]
  v_cmp_ne_u32 vcc, s52, v33
  s_cbranch_vccz L_p3_ok
L_p3_loop:
  buffer_load_dword v33, v39, s[32:35], s101 offen sc1
  s_add_u32 s65, s65, 1
  s_cmp_ge_u32 s65, 0x20000
  s_cbranch_scc1 L_p3_ok
  s_waitcnt vmcnt(0)
  v_cmp_ne_u32 vcc, s52, v33
  s_cbranch_vccz L_p3_ok
  s_sleep 4
  s_branch L_p3_loop
L_p3_ok:
  s_add_u32 s4, s4, 114688
  s_add_u32 s61, s4, s8
  buffer_load_dwordx4 v[176:179], v12, s[32:35], s61 offen sc1
  v_mfma_f32_32x32x16_bf16 v[64:79], v[132:135], a[136:139], v[64:79]
  s_waitcnt vmcnt(10)
  v_mfma_f32_32x32x16_bf16 v[80:95], v[136:139], a[148:151], v[80:95]
  s_add_u32 s5, s5, 114688
  s_add_u32 s61, s5, s8
  buffer_load_dwordx4 v[180:183], v12, s[32:35], s61 offen sc1
  v_mfma_f32_32x32x16_bf16 v[64:79], v[136:139], a[144:147], v[64:79]
  s_waitcnt vmcnt(10)
  v_mfma_f32_32x32x16_bf16 v[80:95], v[140:143], a[156:159], v[80:95]
  s_add_u32 s6, s6, 114688
  s_add_u32 s61, s6, s8
  buffer_load_dwordx4 v[184:187], v12, s[32:35], s61 offen sc1
  v_mfma_f32_32x32x16_bf16 v[64:79], v[140:143], a[152:155], v[64:79]
  s_waitcnt vmcnt(10)
  v_mfma_f32_32x32x16_bf16 v[80:95], v[144:147], a[164:167], v[80:95]
  s_add_u32 s7, s7, 114688
  s_add_u32 s61, s7, s8
  buffer_load_dwordx4 v[188:191], v12, s[32:35], s61 offen sc1
  v_mfma_f32_32x32x16_bf16 v[64:79], v[144:147], a[160:163], v[64:79]
  s_waitcnt vmcnt(10)
  v_mfma_f32_32x32x16_bf16 v[80:95], v[148:151], a[172:175], v[80:95]
  s_add_u32 s61, s4, s9
  buffer_load_dwordx4 v[128:131], v12, s[32:35], s61 offen sc1
  v_mfma_f32_32x32x16_bf16 v[64:79], v[148:151], a[168:171], v[64:79]
  s_waitcnt vmcnt(10)
  v_mfma_f32_32x32x16_bf16 v[80:95], v[152:155], a[180:183], v[80:95]
  s_add_u32 s61, s5, s9
  buffer_load_dwordx4 v[132:135], v12, s[32:35], s61 offen sc1
  v_mfma_f32_32x32x16_bf16 v[64:79], v[152:155], a[176:179], v[64:79]
  s_waitcnt vmcnt(10)
  v_mfma_f32_32x32x16_bf16 v[80:95], v[156:159], a[188:191], v[80:95]
  s_add_u32 s61, s6, s9
  buffer_load_dwordx4 v[136:139], v12, s[32:35], s61 offen sc1
  v_mfma_f32_32x32x16_bf16 v[64:79], v[156:159], a[184:187], v[64:79]
  s_waitcnt vmcnt(10)
  v_mfma_f32_32x32x16_bf16 v[80:95], v[160:163], a[196:199], v[80:95]
  s_add_u32 s61, s7, s9
  buffer_load_dwordx4 v[140:143], v12, s[32:35], s61 offen sc1
  v_mfma_f32_32x32x16_bf16 v[64:79], v[160:163], a[192:195], v[64:79]
  s_waitcnt vmcnt(10)
  v_mfma_f32_32x32x16_bf16 v[80:95], v[164:167], a[204:207], v[80:95]
  s_add_u32 s61, s4, s10
  buffer_load_dwordx4 v[144:147], v12, s[32:35], s61 offen sc1
  v_mfma_f32_32x32x16_bf16 v[64:79], v[164:167], a[200:203], v[64:79]
  s_waitcnt vmcnt(10)
  v_mfma_f32_32x32x16_bf16 v[80:95], v[168:171], a[212:215], v[80:95]
  s_add_u32 s61, s5, s10
  buffer_load_dwordx4 v[148:151], v12, s[32:35], s61 offen sc1
  v_mfma_f32_32x32x16_bf16 v[64:79], v[168:171], a[208:211], v[64:79]
  s_waitcnt vmcnt(10)
  v_mfma_f32_32x32x16_bf16 v[80:95], v[172:175], a[220:223], v[80:95]
  s_add_u32 s61, s6, s10
  buffer_load_dwordx4 v[152:155], v12, s[32:35], s61 offen sc1
  v_mfma_f32_32x32x16_bf16 v[64:79], v[172:175], a[216:219], v[64:79]
  s_waitcnt vmcnt(10)
  v_mfma_f32_32x32x16_bf16 v[112:127], v[176:179], a[4:7], 0
  s_add_u32 s61, s7, s10
  buffer_load_dwordx4 v[156:159], v12, s[32:35], s61 offen sc1
  v_mfma_f32_32x32x16_bf16 v[96:111], v[176:179], a[0:3], 0
  s_waitcnt vmcnt(10)
  v_mfma_f32_32x32x16_bf16 v[112:127], v[180:183], a[12:15], v[112:127]
  s_add_u32 s61, s4, s11
  buffer_load_dwordx4 v[160:163], v12, s[32:35], s61 offen sc1
  v_mfma_f32_32x32x16_bf16 v[96:111], v[180:183], a[8:11], v[96:111]
  s_waitcnt vmcnt(10)
  v_mfma_f32_32x32x16_bf16 v[112:127], v[184:187], a[20:23], v[112:127]
  s_add_u32 s61, s5, s11
  buffer_load_dwordx4 v[164:167], v12, s[32:35], s61 offen sc1
  v_mfma_f32_32x32x16_bf16 v[96:111], v[184:187], a[16:19], v[96:111]
  ds_write_b128 v20, v[88:91] offset:32768
  ds_write_b128 v20, v[92:95] offset:33792
  s_waitcnt vmcnt(10)
  v_mfma_f32_32x32x16_bf16 v[112:127], v[188:191], a[28:31], v[112:127]
  s_add_u32 s61, s6, s11
  buffer_load_dwordx4 v[168:171], v12, s[32:35], s61 offen sc1
  v_mfma_f32_32x32x16_bf16 v[96:111], v[188:191], a[24:27], v[96:111]
  ds_write_b128 v20, v[80:83] offset:30720
  ds_write_b128 v20, v[84:87] offset:31744
  s_waitcnt vmcnt(10)
  v_mfma_f32_32x32x16_bf16 v[112:127], v[128:131], a[36:39], v[112:127]
  s_add_u32 s61, s7, s11
  buffer_load_dwordx4 v[172:175], v12, s[32:35], s61 offen sc1
  v_mfma_f32_32x32x16_bf16 v[96:111], v[128:131], a[32:35], v[96:111]
  ds_write_b128 v20, v[72:75] offset:28672
  ds_write_b128 v20, v[76:79] offset:29696
  s_waitcnt vmcnt(10)
  v_mfma_f32_32x32x16_bf16 v[112:127], v[132:135], a[44:47], v[112:127]
  s_add_u32 s61, s4, s12
  buffer_load_dwordx4 v[176:179], v12, s[32:35], s61 offen sc1
  v_mfma_f32_32x32x16_bf16 v[96:111], v[132:135], a[40:43], v[96:111]
  v_add_f32 v64, v64, v32
  v_add_f32 v65, v65, v32
  v_add_f32 v66, v66, v32
  v_add_f32 v67, v67, v32
  v_add_f32 v68, v68, v32
  v_add_f32 v69, v69, v32
  v_add_f32 v70, v70, v32
  s_waitcnt vmcnt(10)
  v_mfma_f32_32x32x16_bf16 v[112:127], v[136:139], a[52:55], v[112:127]
  s_add_u32 s61, s5, s12
  buffer_load_dwordx4 v[180:183], v12, s[32:35], s61 offen sc1
  v_mfma_f32_32x32x16_bf16 v[96:111], v[136:139], a[48:51], v[96:111]
  v_add_f32 v71, v71, v32
  s_waitcnt vmcnt(10)
  v_mfma_f32_32x32x16_bf16 v[112:127], v[140:143], a[60:63], v[112:127]
  s_add_u32 s61, s6, s12
  buffer_load_dwordx4 v[184:187], v12, s[32:35], s61 offen sc1
  v_mfma_f32_32x32x16_bf16 v[96:111], v[140:143], a[56:59], v[96:111]
  s_waitcnt lgkmcnt(0)
  s_barrier
  ds_read_b128 v[192:195], v21 offset:28672
  ds_read_b128 v[196:199], v21 offset:29696
  ds_read_b128 v[200:203], v22 offset:30720
  ds_read_b128 v[204:207], v22 offset:31744
  ds_read_b128 v[208:211], v23 offset:32768
  ds_read_b128 v[212:215], v23 offset:33792
  s_waitcnt vmcnt(10)
  v_mfma_f32_32x32x16_bf16 v[112:127], v[144:147], a[68:71], v[112:127]
  s_add_u32 s61, s7, s12
  buffer_load_dwordx4 v[188:191], v12, s[32:35], s61 offen sc1
  v_mfma_f32_32x32x16_bf16 v[96:111], v[144:147], a[64:67], v[96:111]
  s_waitcnt vmcnt(10)
  v_mfma_f32_32x32x16_bf16 v[112:127], v[148:151], a[76:79], v[112:127]
  s_add_u32 s61, s4, s13
  buffer_load_dwordx4 v[128:131], v12, s[32:35], s61 offen sc1
  v_mfma_f32_32x32x16_bf16 v[96:111], v[148:151], a[72:75], v[96:111]
  s_waitcnt lgkmcnt(0)
  s_waitcnt vmcnt(10)
  v_mfma_f32_32x32x16_bf16 v[112:127], v[152:155], a[84:87], v[112:127]
  s_add_u32 s61, s5, s13
  buffer_load_dwordx4 v[132:135], v12, s[32:35], s61 offen sc1
  v_mfma_f32_32x32x16_bf16 v[96:111], v[152:155], a[80:83], v[96:111]
  v_add_f32 v192, v192, v200
  v_add_f32 v193, v193, v201
  v_add_f32 v194, v194, v202
  v_add_f32 v195, v195, v203
  v_add_f32 v196, v196, v204
  v_add_f32 v197, v197, v205
  v_add_f32 v198, v198, v206
  s_waitcnt vmcnt(10)
  v_mfma_f32_32x32x16_bf16 v[112:127], v[156:159], a[92:95], v[112:127]
  s_add_u32 s61, s6, s13
  buffer_load_dwordx4 v[136:139], v12, s[32:35], s61 offen sc1
  v_mfma_f32_32x32x16_bf16 v[96:111], v[156:159], a[88:91], v[96:111]
  v_add_f32 v199, v199, v207
  v_add_f32 v64, v64, v208
  v_add_f32 v65, v65, v209
  v_add_f32 v66, v66, v210
  v_add_f32 v67, v67, v211
  v_add_f32 v68, v68, v212
  v_add_f32 v69, v69, v213
  s_waitcnt vmcnt(10)
  v_mfma_f32_32x32x16_bf16 v[112:127], v[160:163], a[100:103], v[112:127]
  s_add_u32 s61, s7, s13
  buffer_load_dwordx4 v[140:143], v12, s[32:35], s61 offen sc1
  v_mfma_f32_32x32x16_bf16 v[96:111], v[160:163], a[96:99], v[96:111]
  v_add_f32 v70, v70, v214
  v_add_f32 v71, v71, v215
  v_add_f32 v64, v64, v192
  v_add_f32 v65, v65, v193
  v_add_f32 v66, v66, v194
  v_add_f32 v67, v67, v195
  v_add_f32 v68, v68, v196
  s_waitcnt vmcnt(10)
  v_mfma_f32_32x32x16_bf16 v[112:127], v[164:167], a[108:111], v[112:127]
  s_add_u32 s61, s4, s14
  buffer_load_dwordx4 v[144:147], v12, s[32:35], s61 offen sc1
  v_mfma_f32_32x32x16_bf16 v[96:111], v[164:167], a[104:107], v[96:111]
  v_add_f32 v69, v69, v197
  v_add_f32 v70, v70, v198
  v_add_f32 v71, v71, v199
  v_cvt_pk_bf16_f32 v216, v64, v65
  v_cvt_pk_bf16_f32 v217, v66, v67
  v_cvt_pk_bf16_f32 v218, v68, v69
  v_cvt_pk_bf16_f32 v219, v70, v71
  s_waitcnt vmcnt(10)
  v_mfma_f32_32x32x16_bf16 v[112:127], v[168:171], a[116:119], v[112:127]
  s_add_u32 s61, s5, s14
  buffer_load_dwordx4 v[148:151], v12, s[32:35], s61 offen sc1
  v_mfma_f32_32x32x16_bf16 v[96:111], v[168:171], a[112:115], v[96:111]
  s_nop 1
  v_permlane32_swap_b32 v216, v218
  v_permlane32_swap_b32 v217, v219
  s_nop 1
  buffer_store_dwordx4 v[216:219], v49, s[36:39], s15 offen offset:0
  s_waitcnt vmcnt(11)
  v_mfma_f32_32x32x16_bf16 v[112:127], v[172:175], a[124:127], v[112:127]
  s_add_u32 s61, s6, s14
  buffer_load_dwordx4 v[152:155], v12, s[32:35], s61 offen sc1
  v_mfma_f32_32x32x16_bf16 v[96:111], v[172:175], a[120:123], v[96:111]
  s_waitcnt vmcnt(11)
  v_mfma_f32_32x32x16_bf16 v[112:127], v[176:179], a[132:135], v[112:127]
  s_add_u32 s61, s7, s14
  buffer_load_dwordx4 v[156:159], v12, s[32:35], s61 offen sc1
  v_mfma_f32_32x32x16_bf16 v[96:111], v[176:179], a[128:131], v[96:111]
  s_waitcnt vmcnt(11)
  v_mfma_f32_32x32x16_bf16 v[112:127], v[180:183], a[140:143], v[112:127]
  v_mfma_f32_32x32x16_bf16 v[96:111], v[180:183], a[136:139], v[96:111]
  s_waitcnt vmcnt(10)
  v_mfma_f32_32x32x16_bf16 v[112:127], v[184:187], a[148:151], v[112:127]
  v_mfma_f32_32x32x16_bf16 v[96:111], v[184:187], a[144:147], v[96:111]
  s_waitcnt vmcnt(9)
  v_mfma_f32_32x32x16_bf16 v[112:127], v[188:191], a[156:159], v[112:127]
  v_mfma_f32_32x32x16_bf16 v[96:111], v[188:191], a[152:155], v[96:111]
  s_waitcnt vmcnt(8)
  v_mfma_f32_32x32x16_bf16 v[112:127], v[128:131], a[164:167], v[112:127]
  v_mfma_f32_32x32x16_bf16 v[96:111], v[128:131], a[160:163], v[96:111]
  s_waitcnt vmcnt(7)
  v_mfma_f32_32x32x16_bf16 v[112:127], v[132:135], a[172:175], v[112:127]
  v_mfma_f32_32x32x16_bf16 v[96:111], v[132:135], a[168:171], v[96:111]
  s_waitcnt vmcnt(6)
  v_mfma_f32_32x32x16_bf16 v[112:127], v[136:139], a[180:183], v[112:127]
  v_mfma_f32_32x32x16_bf16 v[96:111], v[136:139], a[176:179], v[96:111]
  s_waitcnt vmcnt(5)
  v_mfma_f32_32x32x16_bf16 v[112:127], v[140:143], a[188:191], v[112:127]
  v_mfma_f32_32x32x16_bf16 v[96:111], v[140:143], a[184:187], v[96:111]
  s_waitcnt vmcnt(4)
  v_mfma_f32_32x32x16_bf16 v[112:127], v[144:147], a[196:199], v[112:127]
  v_mfma_f32_32x32x16_bf16 v[96:111], v[144:147], a[192:195], v[96:111]
  s_waitcnt vmcnt(3)
  v_mfma_f32_32x32x16_bf16 v[112:127], v[148:151], a[204:207], v[112:127]
  v_mfma_f32_32x32x16_bf16 v[96:111], v[148:151], a[200:203], v[96:111]
  s_waitcnt vmcnt(1)
  v_mfma_f32_32x32x16_bf16 v[112:127], v[152:155], a[212:215], v[112:127]
  v_mfma_f32_32x32x16_bf16 v[96:111], v[152:155], a[208:211], v[96:111]
  s_waitcnt vmcnt(0)
  v_mfma_f32_32x32x16_bf16 v[112:127], v[156:159], a[220:223], v[112:127]
  v_mfma_f32_32x32x16_bf16 v[96:111], v[156:159], a[216:219], v[96:111]
  s_nop 10
  ds_write_b128 v20, v[120:123] offset:38912
  ds_write_b128 v20, v[124:127] offset:39936
  ds_write_b128 v20, v[112:115] offset:36864
  ds_write_b128 v20, v[116:119] offset:37888
  ds_write_b128 v20, v[104:107] offset:34816
  ds_write_b128 v20, v[108:111] offset:35840
  v_add_f32 v96, v96, v32
  v_add_f32 v97, v97, v32
  v_add_f32 v98, v98, v32
  v_add_f32 v99, v99, v32
  v_add_f32 v100, v100, v32
  v_add_f32 v101, v101, v32
  v_add_f32 v102, v102, v32
  v_add_f32 v103, v103, v32
  s_waitcnt lgkmcnt(0)
  s_barrier
  ds_read_b128 v[192:195], v21 offset:34816
  ds_read_b128 v[196:199], v21 offset:35840
  ds_read_b128 v[200:203], v22 offset:36864
  ds_read_b128 v[204:207], v22 offset:37888
  ds_read_b128 v[208:211], v23 offset:38912
  ds_read_b128 v[212:215], v23 offset:39936
  s_waitcnt lgkmcnt(0)
  v_pk_add_f32 v[192:193], v[192:193], v[200:201]
  v_pk_add_f32 v[194:195], v[194:195], v[202:203]
  v_pk_add_f32 v[196:197], v[196:197], v[204:205]
  v_pk_add_f32 v[198:199], v[198:199], v[206:207]
  v_pk_add_f32 v[96:97], v[96:97], v[208:209]
  v_pk_add_f32 v[98:99], v[98:99], v[210:211]
  v_pk_add_f32 v[100:101], v[100:101], v[212:213]
  v_pk_add_f32 v[102:103], v[102:103], v[214:215]
  v_pk_add_f32 v[96:97], v[96:97], v[192:193]
  v_pk_add_f32 v[98:99], v[98:99], v[194:195]
  v_pk_add_f32 v[100:101], v[100:101], v[196:197]
  v_pk_add_f32 v[102:103], v[102:103], v[198:199]
  v_cvt_pk_bf16_f32 v216, v96, v97
  v_cvt_pk_bf16_f32 v217, v98, v99
  v_cvt_pk_bf16_f32 v218, v100, v101
  v_cvt_pk_bf16_f32 v219, v102, v103
  s_nop 1
  v_permlane32_swap_b32 v216, v218
  v_permlane32_swap_b32 v217, v219
  s_nop 1
  buffer_store_dwordx4 v[216:219], v49, s[36:39], s15 offen offset:64
  s_lshl_b32 s66, s2, 2
  s_add_u32 s66, s66, s48
  s_cmp_lg_u32 s66, 128
  s_cbranch_scc1 L_fin
  s_mov_b32 s66, 0x1f8000
  buffer_store_dword v50, v48, s[32:35], s66 offen sc1
L_fin:
L_done:
  s_endpgm
.section .rodata,"a"
.p2align 6
.amdhsa_kernel standalone__mixer_token_mlp__prompt_kernel
  .amdhsa_next_free_vgpr 512
  .amdhsa_next_free_sgpr 102
  .amdhsa_accum_offset 256
  .amdhsa_group_segment_fixed_size 0
  .amdhsa_kernarg_size 64
  .amdhsa_user_sgpr_count 2
  .amdhsa_user_sgpr_kernarg_segment_ptr 1
  .amdhsa_system_sgpr_workgroup_id_x 1
  .amdhsa_float_denorm_mode_32 3
.end_amdhsa_kernel
```
